```python
import torch

def _softmax(x, axis=-1):
    return torch.softmax(x, dim=axis)
def _gelu(x):
    return torch.nn.functional.gelu(x, approximate="tanh")
def _silu(x):
    return torch.nn.functional.silu(x)
def _sigmoid(x):
    return torch.sigmoid(x)
def _layernorm(x, axis=-1, eps=1e-5):
    m = x.mean(dim=axis, keepdim=True)
    v = x.var(dim=axis, keepdim=True, unbiased=False)
    return (x - m) / torch.sqrt(v + eps)
def _scatter_add(tgt, idx, src, axis=0):
    return tgt.clone().index_add_(axis, idx, src)
def _segment_sum(src, seg, n):
    out = torch.zeros((n,) + src.shape[1:], dtype=src.dtype)
    return out.index_add_(0, seg, src)
def _pad(x, pw):
    flat = tuple(v for pair in reversed(pw) for v in pair)
    return torch.nn.functional.pad(x, flat)

kernel_name = 'recurrent_scan__mha_block_cached__swiglu_ffn__decode'

def setup_inputs():

    _w = (lambda a: (lambda t: t.to(torch.bfloat16) if t.is_floating_point() else t)(torch.as_tensor(a)))
    def _A_setup():
        B, Sq, D = 2, 1, 512
        H, Sk, Dh = 32, 16384, 128
        return {
            "x": _w((lambda *s: torch.randn(*s, dtype=torch.bfloat16) * 0.05)(B, Sq, D)),
            "k_cache": _w((lambda *s: torch.randn(*s, dtype=torch.bfloat16) * 1.6)(B, H, Sk, Dh)),
            "v_cache": _w((lambda *s: torch.randn(*s, dtype=torch.bfloat16) * 0.2)(B, H, Sk, Dh)),
            "wq": _w((lambda *s: torch.randn(*s, dtype=torch.bfloat16) * 1.6)(D, H * Dh) * (D ** -0.5)),
            "wo": _w((lambda *s: torch.randn(*s, dtype=torch.bfloat16) * 0.2)(H * Dh, D) * ((H * Dh) ** -0.5)),
        }
    _A_in = _A_setup()

    def _B_setup():
        B, S, D, F = 2, 1, 512, 1792
        return {
            "x": _w((lambda *s: torch.randn(*s, dtype=torch.bfloat16) * 0.05)(B, S, D)),
            "w_gate": _w((lambda *s: torch.randn(*s, dtype=torch.bfloat16) * 0.1)(D, F)),
            "w_up": _w((lambda *s: torch.randn(*s, dtype=torch.bfloat16) * 0.1)(D, F)),
            "w_down": _w((lambda *s: torch.randn(*s, dtype=torch.bfloat16) * 0.1)(F, D)),
        }
    _B_in = _B_setup()

    return {
        "A_x": _A_in["x"],
        "A_k_cache": _A_in["k_cache"],
        "A_v_cache": _A_in["v_cache"],
        "A_wq": _A_in["wq"],
        "A_wo": _A_in["wo"],
        "B_x": _B_in["x"],
        "B_w_gate": _B_in["w_gate"],
        "B_w_up": _B_in["w_up"],
        "B_w_down": _B_in["w_down"],
    }

def reference(A_x, A_k_cache, A_v_cache, A_wq, A_wo, B_x, B_w_gate, B_w_up, B_w_down):
    def _A_ref(x, k_cache, v_cache, wq, wo):
        B, Sq, D = x.shape
        H, Dh = 32, 128
        q = (lambda x, *d: x.permute(*d))((x @ wq).reshape(B, Sq, H, Dh), 0, 2, 1, 3)
        scores = torch.einsum("bhqd,bhkd->bhqk", q, k_cache) * (Dh ** -0.5)
        p = _softmax(scores, axis=-1)
        o = torch.einsum("bhqk,bhkd->bhqd", p, v_cache)
        return (lambda x, *d: x.permute(*d))(o, 0, 2, 1, 3).reshape(B, Sq, H * Dh) @ wo

    def _B_ref(x, w_gate, w_up, w_down):
        g = _silu(x @ w_gate)
        u = x @ w_up
        return (g * u) @ w_down

    x = A_x
    xn = _layernorm(x, axis=-1)
    s = _A_ref(xn, A_k_cache, A_v_cache, A_wq, A_wo)
    g = _silu(_B_ref(xn, B_w_gate, B_w_up, B_w_down))
    return x + s * g
```

```asm
; @launch grid=(256,1,1) block=(512,1,1) lds=160768
.amdgcn_target "amdgcn-amd-amdhsa--gfx950"
.text
.globl recurrent_scan__mha_block_cached__swiglu_ffn__decode_kernel
.p2align 8
.type recurrent_scan__mha_block_cached__swiglu_ffn__decode_kernel,@function
recurrent_scan__mha_block_cached__swiglu_ffn__decode_kernel:
    s_cmp_ge_u32 s2, 256
    s_cbranch_scc1 L_end
    s_load_dwordx16 s[64:79], s[0:1], 0
    s_load_dwordx8 s[80:87], s[0:1], 64
    v_lshrrev_b32 v1, 6, v0
    v_and_b32 v3, 63, v0
    v_readfirstlane_b32 s3, v1
    v_lshlrev_b32 v1, 4, v3
    s_and_b32 s54, s2, 7
    s_lshr_b32 s55, s2, 3
    s_and_b32 s56, s55, 3
    s_bfe_u32 s57, s55, 0x10002
    s_and_b32 s58, s55, 24
    s_or_b32 s58, s58, s54
    s_mov_b32 s14, 0xffff0000
    s_mov_b32 s15, 0x3db504f3
    s_mov_b32 s16, 0x3fb8aa3b
    s_lshr_b32 s59, s54, 1
    s_mul_i32 s59, s59, 7
    s_lshr_b32 s97, s55, 2
    s_add_u32 s59, s59, s97
    s_cmp_lt_u32 s97, 7
    s_cselect_b32 s97, s59, 63
    s_bitcmp1_b32 s54, 0
    s_cselect_b32 s97, 63, s97
    s_cmp_ge_u32 s3, 4
    s_cbranch_scc1 L_aux
    s_lshl_b32 s59, s57, 5
    s_add_u32 s59, s59, s58
    s_lshl_b32 s59, s59, 22
    s_lshl_b32 s12, s3, 12
    v_add_u32 v19, s12, v1
    v_add_u32 v63, 0x4000, v19
    s_lshl_b32 s12, s56, 15
    s_mov_b32 s31, s12
    s_mul_i32 s24, s56, 0xc000
    s_add_u32 s24, s24, 0x3e0000
    s_sub_u32 s30, s24, 0xc000
    s_min_u32 s24, s24, 0x400000
    s_cmp_eq_u32 s56, 0
    s_cselect_b32 s50, -1, 0x3e0000
    s_mov_b32 s18, 0x4042423c
    s_lshl_b32 s17, s56, 3
    s_lshr_b32 s18, s18, s17
    s_and_b32 s18, s18, 0xff
    s_cmp_lt_u32 s97, 28
    s_cselect_b32 s24, s24, 0x400000
    s_cselect_b32 s50, s50, -1
    s_cselect_b32 s18, s18, 64
    s_mov_b32 s29, s50
    s_mov_b32 s28, 0x20000
    s_mov_b32 s51, 0x8000
    s_lshl_b32 s17, s3, 13
    v_add_u32 v19, s17, v1
    v_add_u32 v63, 0x1000, v19
    s_add_u32 s30, s31, 0x3b8000
    s_mov_b32 s51, 0x18000
    s_cmp_eq_u32 s50, -1
    s_cselect_b32 s50, -1, 0x3c0000
    s_mov_b32 s29, s50
    s_mov_b32 s24, 0x400000
    s_cmp_lt_u32 s18, 64
    s_cselect_b32 s24, 0x3c0000, s24
    s_waitcnt lgkmcnt(0)
    s_add_u32 s4, s66, s59
    s_addc_u32 s5, s67, 0
    s_mov_b32 s6, s24
    s_mov_b32 s7, 0x20000
    buffer_load_dwordx4 v[96:99], v19, s[4:7], s12 offen offset:0 nt
    buffer_load_dwordx4 v[100:103], v19, s[4:7], s12 offen offset:1024 nt
    buffer_load_dwordx4 v[104:107], v19, s[4:7], s12 offen offset:2048 nt
    buffer_load_dwordx4 v[108:111], v19, s[4:7], s12 offen offset:3072 nt
    buffer_load_dwordx4 v[112:115], v63, s[4:7], s12 offen offset:0 nt
    buffer_load_dwordx4 v[116:119], v63, s[4:7], s12 offen offset:1024 nt
    v_and_b32 v2, 7, v3
    v_mov_b32 v36, 0xffff
    v_mov_b32 v37, s14
    v_cmp_eq_u32 s[88:89], 0, v2
    v_cmp_eq_u32 vcc, 1, v2
    s_nop 0
    v_cndmask_b32 v8, 0, v36, s[88:89]
    v_cndmask_b32 v8, v8, v37, vcc
    v_cmp_eq_u32 s[88:89], 2, v2
    v_cmp_eq_u32 vcc, 3, v2
    s_nop 0
    v_cndmask_b32 v9, 0, v36, s[88:89]
    v_cndmask_b32 v9, v9, v37, vcc
    v_cmp_eq_u32 s[88:89], 4, v2
    v_cmp_eq_u32 vcc, 5, v2
    s_nop 0
    v_cndmask_b32 v10, 0, v36, s[88:89]
    v_cndmask_b32 v10, v10, v37, vcc
    v_cmp_eq_u32 s[88:89], 6, v2
    v_cmp_eq_u32 vcc, 7, v2
    s_nop 0
    v_cndmask_b32 v11, 0, v36, s[88:89]
    v_cndmask_b32 v11, v11, v37, vcc
    s_add_u32 s8, s66, s59
    s_addc_u32 s9, s67, 0
    s_mov_b32 s10, s24
    s_mov_b32 s11, 0x20000
    s_mov_b32 s20, s86
    s_mov_b32 s21, s87
    s_mov_b32 s22, 1073741824
    s_mov_b32 s23, 0x20000
    s_add_u32 s26, s68, s59
    s_addc_u32 s27, s69, 0
    v_mov_b32 v12, 0
    v_mov_b32 v13, 0
    v_mov_b32 v14, 0
    v_mov_b32 v15, 0
    v_mov_b32 v17, 0xff800000
    v_mov_b32 v18, 0
    v_and_b32 v2, 15, v3
    v_lshlrev_b32 v2, 5, v2
    s_and_b32 s33, s18, 1
    s_add_u32 s18, s18, 1
    s_lshr_b32 s18, s18, 1
    s_lshl_b32 s13, s18, 1
    s_sub_u32 s13, s13, 9
    s_sub_u32 s33, 0, s33
    s_mov_b64 s[92:93], 0
    s_mov_b32 s19, 9
    s_mul_i32 s25, s3, 32768
    s_add_u32 s25, s25, 29696
    v_add_u32 v58, s25, v1
    s_lshl_b32 s59, s3, 2
    v_mov_b32 v56, s59
    s_mul_i32 s59, s3, 4352
    s_add_u32 s59, s59, 12288
    v_lshrrev_b32 v52, 1, v3
    v_lshl_add_u32 v52, v52, 2, s59
    v_add_u32 v53, 1152, v52
    v_mov_b32 v54, v52
    s_mov_b32 s90, 0xcccccccc
    s_mov_b32 s91, 0xcccccccc
    s_mov_b32 s32, 0
    s_mov_b32 s34, 52
    s_mov_b32 s35, 0
    s_mov_b32 s36, 1716224
    s_cmp_eq_u32 s55, 23
    s_cselect_b32 s38, 8, 0
    s_cselect_b32 s39, 1, 0
    s_add_u32 s38, s38, s54
    s_mul_i32 s38, s38, 256
    s_add_u32 s38, s38, 1716224
    s_cmp_eq_u32 s55, 2
    s_cselect_b32 s39, 1, s39
    s_cmp_eq_u32 s3, 0
    s_cselect_b32 s39, s39, 0
    v_lshlrev_b32 v59, 2, v3
    v_mov_b32 v55, 0
    s_cmp_le_u32 s13, 52
    s_cselect_b32 s34, 44, s34
    s_cselect_b32 s59, 16384, 0
    s_add_u32 s36, s36, s59
    s_mov_b32 s47, 0
    s_mov_b32 s48, 0
    s_mov_b32 s49, 0
    buffer_load_dwordx4 v[120:123], v63, s[4:7], s12 offen offset:2048 nt
    buffer_load_dwordx4 v[124:127], v63, s[4:7], s12 offen offset:3072 nt
    s_add_u32 s12, s12, 0x20000
    s_waitcnt vmcnt(7)
    buffer_load_dwordx4 v[128:131], v19, s[4:7], s12 offen offset:0 nt
    s_waitcnt vmcnt(7)
    buffer_load_dwordx4 v[132:135], v19, s[4:7], s12 offen offset:1024 nt
    s_waitcnt vmcnt(7)
    buffer_load_dwordx4 v[136:139], v19, s[4:7], s12 offen offset:2048 nt
    s_waitcnt vmcnt(7)
    buffer_load_dwordx4 v[140:143], v19, s[4:7], s12 offen offset:3072 nt
    s_waitcnt vmcnt(7)
    buffer_load_dwordx4 v[144:147], v63, s[4:7], s12 offen offset:0 nt
    s_waitcnt vmcnt(7)
    buffer_load_dwordx4 v[148:151], v63, s[4:7], s12 offen offset:1024 nt
    s_waitcnt vmcnt(7)
    buffer_load_dwordx4 v[152:155], v63, s[4:7], s12 offen offset:2048 nt
    s_waitcnt vmcnt(7)
    buffer_load_dwordx4 v[156:159], v63, s[4:7], s12 offen offset:3072 nt
    s_add_u32 s12, s12, 0x20000
    s_waitcnt vmcnt(7)
    buffer_load_dwordx4 v[160:163], v19, s[4:7], s12 offen offset:0 nt
    s_waitcnt vmcnt(7)
    buffer_load_dwordx4 v[164:167], v19, s[4:7], s12 offen offset:1024 nt
    s_waitcnt vmcnt(7)
    buffer_load_dwordx4 v[168:171], v19, s[4:7], s12 offen offset:2048 nt
    s_waitcnt vmcnt(7)
    buffer_load_dwordx4 v[172:175], v19, s[4:7], s12 offen offset:3072 nt
    s_waitcnt vmcnt(7)
    buffer_load_dwordx4 v[176:179], v63, s[4:7], s12 offen offset:0 nt
    s_waitcnt vmcnt(7)
    buffer_load_dwordx4 v[180:183], v63, s[4:7], s12 offen offset:1024 nt
    s_waitcnt vmcnt(7)
    buffer_load_dwordx4 v[184:187], v63, s[4:7], s12 offen offset:2048 nt
    s_waitcnt vmcnt(7)
    buffer_load_dwordx4 v[188:191], v63, s[4:7], s12 offen offset:3072 nt
    s_add_u32 s12, s12, 0x20000
    s_waitcnt vmcnt(7)
    buffer_load_dwordx4 v[192:195], v19, s[4:7], s12 offen offset:0 nt
    s_waitcnt vmcnt(7)
    buffer_load_dwordx4 v[196:199], v19, s[4:7], s12 offen offset:1024 nt
    s_waitcnt vmcnt(7)
    buffer_load_dwordx4 v[200:203], v19, s[4:7], s12 offen offset:2048 nt
    s_waitcnt vmcnt(7)
    buffer_load_dwordx4 v[204:207], v19, s[4:7], s12 offen offset:3072 nt
    s_waitcnt vmcnt(7)
    buffer_load_dwordx4 v[208:211], v63, s[4:7], s12 offen offset:0 nt
    s_waitcnt vmcnt(7)
    buffer_load_dwordx4 v[212:215], v63, s[4:7], s12 offen offset:1024 nt
    s_waitcnt vmcnt(7)
    buffer_load_dwordx4 v[216:219], v63, s[4:7], s12 offen offset:2048 nt
    s_waitcnt vmcnt(7)
    buffer_load_dwordx4 v[220:223], v63, s[4:7], s12 offen offset:3072 nt
    s_add_u32 s12, s12, 0x20000
    s_waitcnt vmcnt(7)
    buffer_load_dwordx4 v[224:227], v19, s[4:7], s12 offen offset:0 nt
    s_waitcnt vmcnt(7)
    buffer_load_dwordx4 v[228:231], v19, s[4:7], s12 offen offset:1024 nt
    s_waitcnt vmcnt(7)
    buffer_load_dwordx4 v[232:235], v19, s[4:7], s12 offen offset:2048 nt
    s_waitcnt vmcnt(7)
    buffer_load_dwordx4 v[236:239], v19, s[4:7], s12 offen offset:3072 nt
    s_waitcnt vmcnt(7)
    buffer_load_dwordx4 v[240:243], v63, s[4:7], s12 offen offset:0 nt
    s_waitcnt vmcnt(7)
    buffer_load_dwordx4 v[244:247], v63, s[4:7], s12 offen offset:1024 nt
    s_waitcnt vmcnt(7)
    buffer_load_dwordx4 v[248:251], v63, s[4:7], s12 offen offset:2048 nt
    s_waitcnt vmcnt(7)
    buffer_load_dwordx4 v[252:255], v63, s[4:7], s12 offen offset:3072 nt
    s_add_u32 s12, s12, 0x20000
    s_mov_b32 s17, 4
L_xl:
    s_mov_b32 m0, s25
    s_add_u32 s25, s25, 4096
    s_waitcnt vmcnt(7)
    buffer_load_dwordx4 v19, s[4:7], s12 offen offset:0 nt lds
    s_waitcnt vmcnt(7)
    buffer_load_dwordx4 v19, s[4:7], s12 offen offset:1024 nt lds
    s_waitcnt vmcnt(7)
    buffer_load_dwordx4 v19, s[4:7], s12 offen offset:2048 nt lds
    s_waitcnt vmcnt(7)
    buffer_load_dwordx4 v19, s[4:7], s12 offen offset:3072 nt lds
    s_mov_b32 m0, s25
    s_add_u32 s25, s25, 4096
    s_waitcnt vmcnt(7)
    buffer_load_dwordx4 v63, s[4:7], s12 offen offset:0 nt lds
    s_waitcnt vmcnt(7)
    buffer_load_dwordx4 v63, s[4:7], s12 offen offset:1024 nt lds
    s_waitcnt vmcnt(7)
    buffer_load_dwordx4 v63, s[4:7], s12 offen offset:2048 nt lds
    s_waitcnt vmcnt(7)
    buffer_load_dwordx4 v63, s[4:7], s12 offen offset:3072 nt lds
    s_add_u32 s12, s12, 0x20000
    s_sub_u32 s17, s17, 1
    s_cmp_lg_u32 s17, 0
    s_cbranch_scc1 L_xl
    s_waitcnt vmcnt(6)
    buffer_load_dwordx4 v[64:67], v19, s[4:7], s12 offen offset:0 nt
    s_waitcnt vmcnt(6)
    buffer_load_dwordx4 v[68:71], v19, s[4:7], s12 offen offset:1024 nt
    s_waitcnt vmcnt(6)
    buffer_load_dwordx4 v[72:75], v19, s[4:7], s12 offen offset:2048 nt
    s_waitcnt vmcnt(6)
    buffer_load_dwordx4 v[76:79], v19, s[4:7], s12 offen offset:3072 nt
    s_waitcnt vmcnt(6)
    buffer_load_dwordx4 v[80:83], v63, s[4:7], s12 offen offset:0 nt
    s_waitcnt vmcnt(6)
    buffer_load_dwordx4 v[84:87], v63, s[4:7], s12 offen offset:1024 nt
    s_waitcnt vmcnt(6)
    buffer_load_dwordx4 v[88:91], v63, s[4:7], s12 offen offset:2048 nt
    s_add_u32 s17, s12, 0x20000
    s_barrier
    ds_read_b128 v[20:23], v2 offset:0
    ds_read_b128 v[24:27], v2 offset:16
    ds_read_b128 v[28:31], v2 offset:512
    ds_read_b128 v[32:35], v2 offset:528
    ds_read_b128 v[36:39], v2 offset:1024
    ds_read_b128 v[40:43], v2 offset:1040
    ds_read_b128 v[44:47], v2 offset:1536
    ds_read_b128 v[48:51], v2 offset:1552
    s_waitcnt lgkmcnt(0)
    v_add_f32 v20, v20, v28
    v_add_f32 v36, v36, v44
    v_add_f32 v21, v21, v29
    v_add_f32 v37, v37, v45
    v_add_f32 v22, v22, v30
    v_add_f32 v38, v38, v46
    v_add_f32 v23, v23, v31
    v_add_f32 v39, v39, v47
    v_add_f32 v24, v24, v32
    v_add_f32 v40, v40, v48
    v_add_f32 v25, v25, v33
    v_add_f32 v41, v41, v49
    v_add_f32 v26, v26, v34
    v_add_f32 v42, v42, v50
    v_add_f32 v27, v27, v35
    v_add_f32 v43, v43, v51
    v_add_f32 v20, v20, v36
    v_add_f32 v21, v21, v37
    v_add_f32 v22, v22, v38
    v_add_f32 v23, v23, v39
    v_add_f32 v24, v24, v40
    v_add_f32 v25, v25, v41
    v_add_f32 v26, v26, v42
    v_add_f32 v27, v27, v43
    v_cvt_pk_bf16_f32 v4, v20, v21
    v_cvt_pk_bf16_f32 v5, v22, v23
    v_cvt_pk_bf16_f32 v6, v24, v25
    v_cvt_pk_bf16_f32 v7, v26, v27
    v_mov_b32 v51, 0xff800000
    v_mul_u32_u24 v49, 256, v3
    s_lshl_b32 s59, s3, 10
    v_add_u32 v2, s59, v1
    s_branch L_k_f
L_k_s:
    s_waitcnt vmcnt(3)
    buffer_load_dwordx4 v[92:95], v63, s[4:7], s12 offen offset:3072 nt
    v_dot2_f32_bf16 v20, v64, v4, 0
    v_dot2_f32_bf16 v20, v65, v5, v20
    v_dot2_f32_bf16 v20, v66, v6, v20
    v_dot2_f32_bf16 v20, v67, v7, v20
    s_waitcnt vmcnt(3)
    buffer_load_dwordx4 v[64:67], v19, s[8:11], s17 offen offset:0 nt
    v_dot2_f32_bf16 v21, v68, v4, 0
    v_dot2_f32_bf16 v21, v69, v5, v21
    v_dot2_f32_bf16 v21, v70, v6, v21
    v_dot2_f32_bf16 v21, v71, v7, v21
    s_waitcnt vmcnt(3)
    buffer_load_dwordx4 v[68:71], v19, s[8:11], s17 offen offset:1024 nt
    v_dot2_f32_bf16 v22, v72, v4, 0
    v_dot2_f32_bf16 v22, v73, v5, v22
    v_dot2_f32_bf16 v22, v74, v6, v22
    v_dot2_f32_bf16 v22, v75, v7, v22
    s_waitcnt vmcnt(3)
    buffer_load_dwordx4 v[72:75], v19, s[8:11], s17 offen offset:2048 nt
    v_dot2_f32_bf16 v23, v76, v4, 0
    v_dot2_f32_bf16 v23, v77, v5, v23
    v_dot2_f32_bf16 v23, v78, v6, v23
    v_dot2_f32_bf16 v23, v79, v7, v23
    s_waitcnt vmcnt(3)
    buffer_load_dwordx4 v[76:79], v19, s[8:11], s17 offen offset:3072 nt
    v_dot2_f32_bf16 v24, v80, v4, 0
    v_dot2_f32_bf16 v24, v81, v5, v24
    v_dot2_f32_bf16 v24, v82, v6, v24
    v_dot2_f32_bf16 v24, v83, v7, v24
    v_add_f32_dpp v28, v20, v20 row_ror:8 row_mask:0xf bank_mask:0xf
    v_add_f32_dpp v29, v21, v21 row_ror:8 row_mask:0xf bank_mask:0xf
    s_nop 0
    v_add_f32_dpp v28, v22, v22 row_ror:8 row_mask:0xf bank_mask:0xc
    v_add_f32_dpp v29, v23, v23 row_ror:8 row_mask:0xf bank_mask:0xc
    s_nop 0
    v_add_f32_dpp v30, v28, v28 row_half_mirror row_mask:0xf bank_mask:0xf
    s_nop 1
    v_add_f32_dpp v30, v29, v29 row_half_mirror row_mask:0xf bank_mask:0xa
    s_nop 1
    v_add_f32_dpp v30, v30, v30 quad_perm:[2,3,0,1] row_mask:0xf bank_mask:0xf
    s_waitcnt vmcnt(3)
    buffer_load_dwordx4 v[80:83], v63, s[8:11], s17 offen offset:0 nt
    v_dot2_f32_bf16 v25, v84, v4, 0
    v_dot2_f32_bf16 v25, v85, v5, v25
    v_dot2_f32_bf16 v25, v86, v6, v25
    v_dot2_f32_bf16 v25, v87, v7, v25
    s_waitcnt vmcnt(3)
    buffer_load_dwordx4 v[84:87], v63, s[8:11], s17 offen offset:1024 nt
    v_dot2_f32_bf16 v26, v88, v4, 0
    v_dot2_f32_bf16 v26, v89, v5, v26
    v_dot2_f32_bf16 v26, v90, v6, v26
    v_dot2_f32_bf16 v26, v91, v7, v26
    s_memrealtime s[40:41]
    s_waitcnt vmcnt(3)
    buffer_load_dwordx4 v[88:91], v63, s[8:11], s17 offen offset:2048 nt
    v_dot2_f32_bf16 v27, v92, v4, 0
    v_dot2_f32_bf16 v27, v93, v5, v27
    v_dot2_f32_bf16 v27, v94, v6, v27
    v_dot2_f32_bf16 v27, v95, v7, v27
    v_add_f32_dpp v28, v24, v24 row_ror:8 row_mask:0xf bank_mask:0xf
    v_add_f32_dpp v29, v25, v25 row_ror:8 row_mask:0xf bank_mask:0xf
    s_nop 0
    v_add_f32_dpp v28, v26, v26 row_ror:8 row_mask:0xf bank_mask:0xc
    v_add_f32_dpp v29, v27, v27 row_ror:8 row_mask:0xf bank_mask:0xc
    s_nop 0
    v_add_f32_dpp v31, v28, v28 row_half_mirror row_mask:0xf bank_mask:0xf
    s_nop 1
    v_add_f32_dpp v31, v29, v29 row_half_mirror row_mask:0xf bank_mask:0xa
    s_nop 1
    v_add_f32_dpp v31, v31, v31 quad_perm:[2,3,0,1] row_mask:0xf bank_mask:0xf
    v_cndmask_b32 v30, v30, v31, s[90:91]
    s_nop 1
    v_add_f32_dpp v30, v30, v30 quad_perm:[1,0,3,2] row_mask:0xf bank_mask:0xf
    v_cvt_pk_bf16_f32 v30, v30, v30
    v_and_b32 v30, s14, v30
    v_mul_f32 v30, s15, v30
    v_cvt_pk_bf16_f32 v30, v30, v30
    v_and_b32 v30, s14, v30
    ds_write_b32 v53, v30 offset:0
    v_max_f32 v17, v17, v30
    s_branch L_next
L_k_f:
    s_waitcnt vmcnt(6)
    buffer_load_dwordx4 v[92:95], v63, s[4:7], s12 offen offset:3072 nt
    v_dot2_f32_bf16 v20, v64, v4, 0
    v_dot2_f32_bf16 v20, v65, v5, v20
    v_dot2_f32_bf16 v20, v66, v6, v20
    v_dot2_f32_bf16 v20, v67, v7, v20
    s_waitcnt vmcnt(6)
    buffer_load_dwordx4 v[64:67], v19, s[8:11], s17 offen offset:0 nt
    v_dot2_f32_bf16 v21, v68, v4, 0
    v_dot2_f32_bf16 v21, v69, v5, v21
    v_dot2_f32_bf16 v21, v70, v6, v21
    v_dot2_f32_bf16 v21, v71, v7, v21
    s_waitcnt vmcnt(6)
    buffer_load_dwordx4 v[68:71], v19, s[8:11], s17 offen offset:1024 nt
    v_dot2_f32_bf16 v22, v72, v4, 0
    v_dot2_f32_bf16 v22, v73, v5, v22
    v_dot2_f32_bf16 v22, v74, v6, v22
    v_dot2_f32_bf16 v22, v75, v7, v22
    s_waitcnt vmcnt(6)
    buffer_load_dwordx4 v[72:75], v19, s[8:11], s17 offen offset:2048 nt
    v_dot2_f32_bf16 v23, v76, v4, 0
    v_dot2_f32_bf16 v23, v77, v5, v23
    v_dot2_f32_bf16 v23, v78, v6, v23
    v_dot2_f32_bf16 v23, v79, v7, v23
    s_waitcnt vmcnt(6)
    buffer_load_dwordx4 v[76:79], v19, s[8:11], s17 offen offset:3072 nt
    v_dot2_f32_bf16 v24, v80, v4, 0
    v_dot2_f32_bf16 v24, v81, v5, v24
    v_dot2_f32_bf16 v24, v82, v6, v24
    v_dot2_f32_bf16 v24, v83, v7, v24
    v_add_f32_dpp v28, v20, v20 row_ror:8 row_mask:0xf bank_mask:0xf
    v_add_f32_dpp v29, v21, v21 row_ror:8 row_mask:0xf bank_mask:0xf
    s_nop 0
    v_add_f32_dpp v28, v22, v22 row_ror:8 row_mask:0xf bank_mask:0xc
    v_add_f32_dpp v29, v23, v23 row_ror:8 row_mask:0xf bank_mask:0xc
    s_nop 0
    v_add_f32_dpp v30, v28, v28 row_half_mirror row_mask:0xf bank_mask:0xf
    s_nop 1
    v_add_f32_dpp v30, v29, v29 row_half_mirror row_mask:0xf bank_mask:0xa
    s_nop 1
    v_add_f32_dpp v30, v30, v30 quad_perm:[2,3,0,1] row_mask:0xf bank_mask:0xf
    s_waitcnt vmcnt(6)
    buffer_load_dwordx4 v[80:83], v63, s[8:11], s17 offen offset:0 nt
    v_dot2_f32_bf16 v25, v84, v4, 0
    v_dot2_f32_bf16 v25, v85, v5, v25
    v_dot2_f32_bf16 v25, v86, v6, v25
    v_dot2_f32_bf16 v25, v87, v7, v25
    s_waitcnt vmcnt(6)
    buffer_load_dwordx4 v[84:87], v63, s[8:11], s17 offen offset:1024 nt
    v_dot2_f32_bf16 v26, v88, v4, 0
    v_dot2_f32_bf16 v26, v89, v5, v26
    v_dot2_f32_bf16 v26, v90, v6, v26
    v_dot2_f32_bf16 v26, v91, v7, v26
    s_memrealtime s[40:41]
    s_waitcnt vmcnt(6)
    buffer_load_dwordx4 v[88:91], v63, s[8:11], s17 offen offset:2048 nt
    v_dot2_f32_bf16 v27, v92, v4, 0
    v_dot2_f32_bf16 v27, v93, v5, v27
    v_dot2_f32_bf16 v27, v94, v6, v27
    v_dot2_f32_bf16 v27, v95, v7, v27
    v_add_f32_dpp v28, v24, v24 row_ror:8 row_mask:0xf bank_mask:0xf
    v_add_f32_dpp v29, v25, v25 row_ror:8 row_mask:0xf bank_mask:0xf
    s_nop 0
    v_add_f32_dpp v28, v26, v26 row_ror:8 row_mask:0xf bank_mask:0xc
    v_add_f32_dpp v29, v27, v27 row_ror:8 row_mask:0xf bank_mask:0xc
    s_nop 0
    v_add_f32_dpp v31, v28, v28 row_half_mirror row_mask:0xf bank_mask:0xf
    s_nop 1
    v_add_f32_dpp v31, v29, v29 row_half_mirror row_mask:0xf bank_mask:0xa
    s_nop 1
    v_add_f32_dpp v31, v31, v31 quad_perm:[2,3,0,1] row_mask:0xf bank_mask:0xf
    v_cndmask_b32 v30, v30, v31, s[90:91]
    s_nop 1
    v_add_f32_dpp v30, v30, v30 quad_perm:[1,0,3,2] row_mask:0xf bank_mask:0xf
    v_cvt_pk_bf16_f32 v30, v30, v30
    v_and_b32 v30, s14, v30
    v_mul_f32 v30, s15, v30
    v_cvt_pk_bf16_f32 v30, v30, v30
    v_and_b32 v30, s14, v30
    ds_write_b32 v53, v30 offset:0
    v_max_f32 v17, v17, v30
    s_branch L_next
L_k_n:
    s_waitcnt vmcnt(5)
    buffer_load_dwordx4 v[92:95], v63, s[4:7], s12 offen offset:3072 nt
    v_dot2_f32_bf16 v20, v64, v4, 0
    v_dot2_f32_bf16 v20, v65, v5, v20
    v_dot2_f32_bf16 v20, v66, v6, v20
    v_dot2_f32_bf16 v20, v67, v7, v20
    s_waitcnt vmcnt(4)
    buffer_load_dwordx4 v[64:67], v19, s[8:11], s17 offen offset:0 nt
    v_dot2_f32_bf16 v21, v68, v4, 0
    v_dot2_f32_bf16 v21, v69, v5, v21
    v_dot2_f32_bf16 v21, v70, v6, v21
    v_dot2_f32_bf16 v21, v71, v7, v21
    s_waitcnt vmcnt(5)
    buffer_load_dwordx4 v[68:71], v19, s[8:11], s17 offen offset:1024 nt
    v_dot2_f32_bf16 v22, v72, v4, 0
    v_dot2_f32_bf16 v22, v73, v5, v22
    v_dot2_f32_bf16 v22, v74, v6, v22
    v_dot2_f32_bf16 v22, v75, v7, v22
    s_waitcnt vmcnt(5)
    buffer_load_dwordx4 v[72:75], v19, s[8:11], s17 offen offset:2048 nt
    v_dot2_f32_bf16 v23, v76, v4, 0
    v_dot2_f32_bf16 v23, v77, v5, v23
    v_dot2_f32_bf16 v23, v78, v6, v23
    v_dot2_f32_bf16 v23, v79, v7, v23
    s_waitcnt vmcnt(5)
    buffer_load_dwordx4 v[76:79], v19, s[8:11], s17 offen offset:3072 nt
    v_dot2_f32_bf16 v24, v80, v4, 0
    v_dot2_f32_bf16 v24, v81, v5, v24
    v_dot2_f32_bf16 v24, v82, v6, v24
    v_dot2_f32_bf16 v24, v83, v7, v24
    v_add_f32_dpp v28, v20, v20 row_ror:8 row_mask:0xf bank_mask:0xf
    v_add_f32_dpp v29, v21, v21 row_ror:8 row_mask:0xf bank_mask:0xf
    s_nop 0
    v_add_f32_dpp v28, v22, v22 row_ror:8 row_mask:0xf bank_mask:0xc
    v_add_f32_dpp v29, v23, v23 row_ror:8 row_mask:0xf bank_mask:0xc
    s_nop 0
    v_add_f32_dpp v30, v28, v28 row_half_mirror row_mask:0xf bank_mask:0xf
    s_nop 1
    v_add_f32_dpp v30, v29, v29 row_half_mirror row_mask:0xf bank_mask:0xa
    s_nop 1
    v_add_f32_dpp v30, v30, v30 quad_perm:[2,3,0,1] row_mask:0xf bank_mask:0xf
    s_waitcnt vmcnt(4)
    buffer_load_dwordx4 v[80:83], v63, s[8:11], s17 offen offset:0 nt
    v_dot2_f32_bf16 v25, v84, v4, 0
    v_dot2_f32_bf16 v25, v85, v5, v25
    v_dot2_f32_bf16 v25, v86, v6, v25
    v_dot2_f32_bf16 v25, v87, v7, v25
    s_waitcnt vmcnt(5)
    buffer_load_dwordx4 v[84:87], v63, s[8:11], s17 offen offset:1024 nt
    v_dot2_f32_bf16 v26, v88, v4, 0
    v_dot2_f32_bf16 v26, v89, v5, v26
    v_dot2_f32_bf16 v26, v90, v6, v26
    v_dot2_f32_bf16 v26, v91, v7, v26
    s_memrealtime s[40:41]
    s_waitcnt vmcnt(5)
    buffer_load_dwordx4 v[88:91], v63, s[8:11], s17 offen offset:2048 nt
    v_dot2_f32_bf16 v27, v92, v4, 0
    v_dot2_f32_bf16 v27, v93, v5, v27
    v_dot2_f32_bf16 v27, v94, v6, v27
    v_dot2_f32_bf16 v27, v95, v7, v27
    v_add_f32_dpp v28, v24, v24 row_ror:8 row_mask:0xf bank_mask:0xf
    v_add_f32_dpp v29, v25, v25 row_ror:8 row_mask:0xf bank_mask:0xf
    s_nop 0
    v_add_f32_dpp v28, v26, v26 row_ror:8 row_mask:0xf bank_mask:0xc
    v_add_f32_dpp v29, v27, v27 row_ror:8 row_mask:0xf bank_mask:0xc
    s_nop 0
    v_add_f32_dpp v31, v28, v28 row_half_mirror row_mask:0xf bank_mask:0xf
    s_nop 1
    v_add_f32_dpp v31, v29, v29 row_half_mirror row_mask:0xf bank_mask:0xa
    s_nop 1
    v_add_f32_dpp v31, v31, v31 quad_perm:[2,3,0,1] row_mask:0xf bank_mask:0xf
    v_cndmask_b32 v30, v30, v31, s[90:91]
    s_nop 1
    v_add_f32_dpp v30, v30, v30 quad_perm:[1,0,3,2] row_mask:0xf bank_mask:0xf
    v_cvt_pk_bf16_f32 v30, v30, v30
    v_and_b32 v30, s14, v30
    v_mul_f32 v30, s15, v30
    v_cvt_pk_bf16_f32 v30, v30, v30
    v_and_b32 v30, s14, v30
    ds_write_b32 v53, v30 offset:0
    v_max_f32 v17, v17, v30
    s_branch L_next
L_v_s:
    ds_read_b32 v26, v53 offset:128
    v_and_b32_dpp v28, v27, v8 row_newbcast:0 row_mask:0xf bank_mask:0xf
    v_and_b32_dpp v29, v27, v9 row_newbcast:0 row_mask:0xf bank_mask:0xf
    v_and_b32_dpp v30, v27, v10 row_newbcast:0 row_mask:0xf bank_mask:0xf
    v_and_b32_dpp v31, v27, v11 row_newbcast:0 row_mask:0xf bank_mask:0xf
    s_waitcnt vmcnt(3)
    buffer_load_dwordx4 v[92:95], v63, s[4:7], s12 offen offset:3072 nt
    v_and_b32_dpp v32, v27, v8 row_newbcast:4 row_mask:0xf bank_mask:0xf
    v_and_b32_dpp v33, v27, v9 row_newbcast:4 row_mask:0xf bank_mask:0xf
    v_and_b32_dpp v34, v27, v10 row_newbcast:4 row_mask:0xf bank_mask:0xf
    v_and_b32_dpp v35, v27, v11 row_newbcast:4 row_mask:0xf bank_mask:0xf
    v_mfma_f32_16x16x32_bf16 v[12:15], v[64:67], v[28:31], v[12:15]
    s_waitcnt vmcnt(3)
    buffer_load_dwordx4 v[64:67], v19, s[8:11], s17 offen offset:0 nt
    v_and_b32_dpp v28, v27, v8 row_newbcast:8 row_mask:0xf bank_mask:0xf
    v_and_b32_dpp v29, v27, v9 row_newbcast:8 row_mask:0xf bank_mask:0xf
    v_and_b32_dpp v30, v27, v10 row_newbcast:8 row_mask:0xf bank_mask:0xf
    v_and_b32_dpp v31, v27, v11 row_newbcast:8 row_mask:0xf bank_mask:0xf
    v_mfma_f32_16x16x32_bf16 v[12:15], v[68:71], v[32:35], v[12:15]
    s_waitcnt vmcnt(3)
    buffer_load_dwordx4 v[68:71], v19, s[8:11], s17 offen offset:1024 nt
    v_and_b32_dpp v32, v27, v8 row_newbcast:12 row_mask:0xf bank_mask:0xf
    v_and_b32_dpp v33, v27, v9 row_newbcast:12 row_mask:0xf bank_mask:0xf
    v_and_b32_dpp v34, v27, v10 row_newbcast:12 row_mask:0xf bank_mask:0xf
    v_and_b32_dpp v35, v27, v11 row_newbcast:12 row_mask:0xf bank_mask:0xf
    v_mfma_f32_16x16x32_bf16 v[12:15], v[72:75], v[28:31], v[12:15]
    s_waitcnt vmcnt(3)
    buffer_load_dwordx4 v[72:75], v19, s[8:11], s17 offen offset:2048 nt
    v_and_b32_dpp v28, v27, v8 row_newbcast:2 row_mask:0xf bank_mask:0xf
    v_and_b32_dpp v29, v27, v9 row_newbcast:2 row_mask:0xf bank_mask:0xf
    v_and_b32_dpp v30, v27, v10 row_newbcast:2 row_mask:0xf bank_mask:0xf
    v_and_b32_dpp v31, v27, v11 row_newbcast:2 row_mask:0xf bank_mask:0xf
    v_mfma_f32_16x16x32_bf16 v[12:15], v[76:79], v[32:35], v[12:15]
    s_waitcnt vmcnt(3)
    buffer_load_dwordx4 v[76:79], v19, s[8:11], s17 offen offset:3072 nt
    v_and_b32_dpp v32, v27, v8 row_newbcast:6 row_mask:0xf bank_mask:0xf
    v_and_b32_dpp v33, v27, v9 row_newbcast:6 row_mask:0xf bank_mask:0xf
    v_and_b32_dpp v34, v27, v10 row_newbcast:6 row_mask:0xf bank_mask:0xf
    v_and_b32_dpp v35, v27, v11 row_newbcast:6 row_mask:0xf bank_mask:0xf
    v_mfma_f32_16x16x32_bf16 v[12:15], v[80:83], v[28:31], v[12:15]
    s_waitcnt vmcnt(3)
    buffer_load_dwordx4 v[80:83], v63, s[8:11], s17 offen offset:0 nt
    v_and_b32_dpp v28, v27, v8 row_newbcast:10 row_mask:0xf bank_mask:0xf
    v_and_b32_dpp v29, v27, v9 row_newbcast:10 row_mask:0xf bank_mask:0xf
    v_and_b32_dpp v30, v27, v10 row_newbcast:10 row_mask:0xf bank_mask:0xf
    v_and_b32_dpp v31, v27, v11 row_newbcast:10 row_mask:0xf bank_mask:0xf
    v_mfma_f32_16x16x32_bf16 v[12:15], v[84:87], v[32:35], v[12:15]
    s_waitcnt vmcnt(3)
    buffer_load_dwordx4 v[84:87], v63, s[8:11], s17 offen offset:1024 nt
    v_and_b32_dpp v32, v27, v8 row_newbcast:14 row_mask:0xf bank_mask:0xf
    v_and_b32_dpp v33, v27, v9 row_newbcast:14 row_mask:0xf bank_mask:0xf
    v_and_b32_dpp v34, v27, v10 row_newbcast:14 row_mask:0xf bank_mask:0xf
    v_and_b32_dpp v35, v27, v11 row_newbcast:14 row_mask:0xf bank_mask:0xf
    v_mfma_f32_16x16x32_bf16 v[12:15], v[88:91], v[28:31], v[12:15]
    s_memrealtime s[40:41]
    s_waitcnt vmcnt(3)
    buffer_load_dwordx4 v[88:91], v63, s[8:11], s17 offen offset:2048 nt
    v_mfma_f32_16x16x32_bf16 v[12:15], v[92:95], v[32:35], v[12:15]
    s_branch L_next
L_v_f:
    ds_read_b32 v26, v53 offset:128
    v_and_b32_dpp v28, v27, v8 row_newbcast:0 row_mask:0xf bank_mask:0xf
    v_and_b32_dpp v29, v27, v9 row_newbcast:0 row_mask:0xf bank_mask:0xf
    v_and_b32_dpp v30, v27, v10 row_newbcast:0 row_mask:0xf bank_mask:0xf
    v_and_b32_dpp v31, v27, v11 row_newbcast:0 row_mask:0xf bank_mask:0xf
    s_waitcnt vmcnt(6)
    buffer_load_dwordx4 v[92:95], v63, s[4:7], s12 offen offset:3072 nt
    v_and_b32_dpp v32, v27, v8 row_newbcast:4 row_mask:0xf bank_mask:0xf
    v_and_b32_dpp v33, v27, v9 row_newbcast:4 row_mask:0xf bank_mask:0xf
    v_and_b32_dpp v34, v27, v10 row_newbcast:4 row_mask:0xf bank_mask:0xf
    v_and_b32_dpp v35, v27, v11 row_newbcast:4 row_mask:0xf bank_mask:0xf
    v_mfma_f32_16x16x32_bf16 v[12:15], v[64:67], v[28:31], v[12:15]
    s_waitcnt vmcnt(6)
    buffer_load_dwordx4 v[64:67], v19, s[8:11], s17 offen offset:0 nt
    v_and_b32_dpp v28, v27, v8 row_newbcast:8 row_mask:0xf bank_mask:0xf
    v_and_b32_dpp v29, v27, v9 row_newbcast:8 row_mask:0xf bank_mask:0xf
    v_and_b32_dpp v30, v27, v10 row_newbcast:8 row_mask:0xf bank_mask:0xf
    v_and_b32_dpp v31, v27, v11 row_newbcast:8 row_mask:0xf bank_mask:0xf
    v_mfma_f32_16x16x32_bf16 v[12:15], v[68:71], v[32:35], v[12:15]
    s_waitcnt vmcnt(6)
    buffer_load_dwordx4 v[68:71], v19, s[8:11], s17 offen offset:1024 nt
    v_and_b32_dpp v32, v27, v8 row_newbcast:12 row_mask:0xf bank_mask:0xf
    v_and_b32_dpp v33, v27, v9 row_newbcast:12 row_mask:0xf bank_mask:0xf
    v_and_b32_dpp v34, v27, v10 row_newbcast:12 row_mask:0xf bank_mask:0xf
    v_and_b32_dpp v35, v27, v11 row_newbcast:12 row_mask:0xf bank_mask:0xf
    v_mfma_f32_16x16x32_bf16 v[12:15], v[72:75], v[28:31], v[12:15]
    s_waitcnt vmcnt(6)
    buffer_load_dwordx4 v[72:75], v19, s[8:11], s17 offen offset:2048 nt
    v_and_b32_dpp v28, v27, v8 row_newbcast:2 row_mask:0xf bank_mask:0xf
    v_and_b32_dpp v29, v27, v9 row_newbcast:2 row_mask:0xf bank_mask:0xf
    v_and_b32_dpp v30, v27, v10 row_newbcast:2 row_mask:0xf bank_mask:0xf
    v_and_b32_dpp v31, v27, v11 row_newbcast:2 row_mask:0xf bank_mask:0xf
    v_mfma_f32_16x16x32_bf16 v[12:15], v[76:79], v[32:35], v[12:15]
    s_waitcnt vmcnt(6)
    buffer_load_dwordx4 v[76:79], v19, s[8:11], s17 offen offset:3072 nt
    v_and_b32_dpp v32, v27, v8 row_newbcast:6 row_mask:0xf bank_mask:0xf
    v_and_b32_dpp v33, v27, v9 row_newbcast:6 row_mask:0xf bank_mask:0xf
    v_and_b32_dpp v34, v27, v10 row_newbcast:6 row_mask:0xf bank_mask:0xf
    v_and_b32_dpp v35, v27, v11 row_newbcast:6 row_mask:0xf bank_mask:0xf
    v_mfma_f32_16x16x32_bf16 v[12:15], v[80:83], v[28:31], v[12:15]
    s_waitcnt vmcnt(6)
    buffer_load_dwordx4 v[80:83], v63, s[8:11], s17 offen offset:0 nt
    v_and_b32_dpp v28, v27, v8 row_newbcast:10 row_mask:0xf bank_mask:0xf
    v_and_b32_dpp v29, v27, v9 row_newbcast:10 row_mask:0xf bank_mask:0xf
    v_and_b32_dpp v30, v27, v10 row_newbcast:10 row_mask:0xf bank_mask:0xf
    v_and_b32_dpp v31, v27, v11 row_newbcast:10 row_mask:0xf bank_mask:0xf
    v_mfma_f32_16x16x32_bf16 v[12:15], v[84:87], v[32:35], v[12:15]
    s_waitcnt vmcnt(6)
    buffer_load_dwordx4 v[84:87], v63, s[8:11], s17 offen offset:1024 nt
    v_and_b32_dpp v32, v27, v8 row_newbcast:14 row_mask:0xf bank_mask:0xf
    v_and_b32_dpp v33, v27, v9 row_newbcast:14 row_mask:0xf bank_mask:0xf
    v_and_b32_dpp v34, v27, v10 row_newbcast:14 row_mask:0xf bank_mask:0xf
    v_and_b32_dpp v35, v27, v11 row_newbcast:14 row_mask:0xf bank_mask:0xf
    v_mfma_f32_16x16x32_bf16 v[12:15], v[88:91], v[28:31], v[12:15]
    s_memrealtime s[40:41]
    s_waitcnt vmcnt(6)
    buffer_load_dwordx4 v[88:91], v63, s[8:11], s17 offen offset:2048 nt
    v_mfma_f32_16x16x32_bf16 v[12:15], v[92:95], v[32:35], v[12:15]
    s_branch L_next
L_v_n:
    ds_read_b32 v26, v53 offset:128
    v_and_b32_dpp v28, v27, v8 row_newbcast:0 row_mask:0xf bank_mask:0xf
    v_and_b32_dpp v29, v27, v9 row_newbcast:0 row_mask:0xf bank_mask:0xf
    v_and_b32_dpp v30, v27, v10 row_newbcast:0 row_mask:0xf bank_mask:0xf
    v_and_b32_dpp v31, v27, v11 row_newbcast:0 row_mask:0xf bank_mask:0xf
    s_waitcnt vmcnt(5)
    buffer_load_dwordx4 v[92:95], v63, s[4:7], s12 offen offset:3072 nt
    v_and_b32_dpp v32, v27, v8 row_newbcast:4 row_mask:0xf bank_mask:0xf
    v_and_b32_dpp v33, v27, v9 row_newbcast:4 row_mask:0xf bank_mask:0xf
    v_and_b32_dpp v34, v27, v10 row_newbcast:4 row_mask:0xf bank_mask:0xf
    v_and_b32_dpp v35, v27, v11 row_newbcast:4 row_mask:0xf bank_mask:0xf
    v_mfma_f32_16x16x32_bf16 v[12:15], v[64:67], v[28:31], v[12:15]
    s_waitcnt vmcnt(4)
    buffer_load_dwordx4 v[64:67], v19, s[8:11], s17 offen offset:0 nt
    v_and_b32_dpp v28, v27, v8 row_newbcast:8 row_mask:0xf bank_mask:0xf
    v_and_b32_dpp v29, v27, v9 row_newbcast:8 row_mask:0xf bank_mask:0xf
    v_and_b32_dpp v30, v27, v10 row_newbcast:8 row_mask:0xf bank_mask:0xf
    v_and_b32_dpp v31, v27, v11 row_newbcast:8 row_mask:0xf bank_mask:0xf
    v_mfma_f32_16x16x32_bf16 v[12:15], v[68:71], v[32:35], v[12:15]
    s_waitcnt vmcnt(5)
    buffer_load_dwordx4 v[68:71], v19, s[8:11], s17 offen offset:1024 nt
    v_and_b32_dpp v32, v27, v8 row_newbcast:12 row_mask:0xf bank_mask:0xf
    v_and_b32_dpp v33, v27, v9 row_newbcast:12 row_mask:0xf bank_mask:0xf
    v_and_b32_dpp v34, v27, v10 row_newbcast:12 row_mask:0xf bank_mask:0xf
    v_and_b32_dpp v35, v27, v11 row_newbcast:12 row_mask:0xf bank_mask:0xf
    v_mfma_f32_16x16x32_bf16 v[12:15], v[72:75], v[28:31], v[12:15]
    s_waitcnt vmcnt(5)
    buffer_load_dwordx4 v[72:75], v19, s[8:11], s17 offen offset:2048 nt
    v_and_b32_dpp v28, v27, v8 row_newbcast:2 row_mask:0xf bank_mask:0xf
    v_and_b32_dpp v29, v27, v9 row_newbcast:2 row_mask:0xf bank_mask:0xf
    v_and_b32_dpp v30, v27, v10 row_newbcast:2 row_mask:0xf bank_mask:0xf
    v_and_b32_dpp v31, v27, v11 row_newbcast:2 row_mask:0xf bank_mask:0xf
    v_mfma_f32_16x16x32_bf16 v[12:15], v[76:79], v[32:35], v[12:15]
    s_waitcnt vmcnt(5)
    buffer_load_dwordx4 v[76:79], v19, s[8:11], s17 offen offset:3072 nt
    v_and_b32_dpp v32, v27, v8 row_newbcast:6 row_mask:0xf bank_mask:0xf
    v_and_b32_dpp v33, v27, v9 row_newbcast:6 row_mask:0xf bank_mask:0xf
    v_and_b32_dpp v34, v27, v10 row_newbcast:6 row_mask:0xf bank_mask:0xf
    v_and_b32_dpp v35, v27, v11 row_newbcast:6 row_mask:0xf bank_mask:0xf
    v_mfma_f32_16x16x32_bf16 v[12:15], v[80:83], v[28:31], v[12:15]
    s_waitcnt vmcnt(4)
    buffer_load_dwordx4 v[80:83], v63, s[8:11], s17 offen offset:0 nt
    v_and_b32_dpp v28, v27, v8 row_newbcast:10 row_mask:0xf bank_mask:0xf
    v_and_b32_dpp v29, v27, v9 row_newbcast:10 row_mask:0xf bank_mask:0xf
    v_and_b32_dpp v30, v27, v10 row_newbcast:10 row_mask:0xf bank_mask:0xf
    v_and_b32_dpp v31, v27, v11 row_newbcast:10 row_mask:0xf bank_mask:0xf
    v_mfma_f32_16x16x32_bf16 v[12:15], v[84:87], v[32:35], v[12:15]
    s_waitcnt vmcnt(5)
    buffer_load_dwordx4 v[84:87], v63, s[8:11], s17 offen offset:1024 nt
    v_and_b32_dpp v32, v27, v8 row_newbcast:14 row_mask:0xf bank_mask:0xf
    v_and_b32_dpp v33, v27, v9 row_newbcast:14 row_mask:0xf bank_mask:0xf
    v_and_b32_dpp v34, v27, v10 row_newbcast:14 row_mask:0xf bank_mask:0xf
    v_and_b32_dpp v35, v27, v11 row_newbcast:14 row_mask:0xf bank_mask:0xf
    v_mfma_f32_16x16x32_bf16 v[12:15], v[88:91], v[28:31], v[12:15]
    s_memrealtime s[40:41]
    s_waitcnt vmcnt(5)
    buffer_load_dwordx4 v[88:91], v63, s[8:11], s17 offen offset:2048 nt
    v_mfma_f32_16x16x32_bf16 v[12:15], v[92:95], v[32:35], v[12:15]
L_next:
    s_waitcnt lgkmcnt(0)
    s_mov_b64 s[4:5], s[8:9]
    s_mov_b32 s12, s17
    s_add_u32 s17, s17, s28
    s_cmp_ge_u32 s17, s29
    s_cselect_b32 s17, s30, s17
    s_cselect_b32 s28, s51, s28
    s_cselect_b32 s29, -1, s29
    s_sub_u32 s13, s13, 1
    v_add_u32 v53, 128, v53
    v_fma_f32 v27, v26, s16, -v16
    v_mov_b32 v57, s13
    v_exp_f32 v27, v27
    ds_write_b32 v56, v57 offset:6192
    s_cmp_eq_u32 s13, 0
    s_cbranch_scc1 L_wfin
    s_add_u32 s47, s47, s48
    s_cmp_eq_u32 s13, s34
    s_cbranch_scc1 L_event
L_disp:
    s_lshl_b32 s45, s40, 3
    s_sub_u32 s45, s45, s47
    s_cmp_eq_u32 s48, 0
    s_cselect_b32 s45, 0, s45
    s_cmp_ge_u32 s13, s18
    s_cbranch_scc1 L_dispk
L_dispv:
    v_add_f32 v18, v18, v27
    v_cvt_pk_bf16_f32 v27, v27, v27
    s_cmp_eq_u32 s13, 1
    s_cbranch_scc1 L_lastv
    s_cmp_lt_i32 s45, -240
    s_cbranch_scc1 L_v_s
    s_cmp_gt_i32 s45, 240
    s_cbranch_scc1 L_v_f
    s_branch L_v_n
L_dispk:
    s_cmp_eq_u32 s13, s18
    s_cbranch_scc1 L_switch
    s_cmp_lg_u32 s19, 0
    s_cbranch_scc1 L_extra
    s_sub_u32 s59, s13, s18
    s_cmp_gt_u32 s59, 1
    s_cbranch_scc1 L_dk2
    s_mov_b64 s[8:9], s[26:27]
    s_mov_b32 s17, s31
    s_mov_b32 s28, 0x20000
    s_mov_b32 s29, s50
    s_mov_b32 s92, s33
    s_mov_b32 s93, s33
    ds_read_b32 v50, v52
L_dk2:
    s_cmp_lt_i32 s45, -240
    s_cbranch_scc1 L_k_s
    s_cmp_gt_i32 s45, 240
    s_cbranch_scc1 L_k_f
    s_branch L_k_n
L_switch:
    v_mov_b32 v53, v52
    v_max_f32_dpp v17, v17, v17 row_ror:8 row_mask:0xf bank_mask:0xf
    s_nop 1
    v_max_f32_dpp v17, v17, v17 row_ror:4 row_mask:0xf bank_mask:0xf
    s_nop 1
    v_max_f32_dpp v17, v17, v17 row_ror:2 row_mask:0xf bank_mask:0xf
    v_mov_b32 v36, v17
    s_nop 1
    v_permlane16_swap_b32 v17, v36
    v_max_f32 v17, v17, v36
    v_mov_b32 v36, v17
    s_nop 1
    v_permlane32_swap_b32 v17, v36
    v_max_f32 v17, v17, v36
    v_mul_f32 v16, s16, v17
    ds_write_b32 v56, v17 offset:6144
    v_fma_f32 v27, v50, s16, -v16
    v_exp_f32 v27, v27
    s_nop 0
    s_branch L_dispv
L_event:
    s_cmp_eq_u32 s35, 1
    s_cbranch_scc1 L_ev1
    s_cmp_eq_u32 s35, 2
    s_cbranch_scc1 L_ev2
    s_mov_b32 s35, 1
    s_sub_u32 s34, s13, 4
    s_cmp_eq_u32 s39, 0
    s_cbranch_scc1 L_disp
    v_mov_b32 v57, s40
    buffer_store_dword v57, v59, s[20:23], s38 offen sc1
    s_mov_b64 exec, -1
    s_add_u32 s38, s38, 16384
    s_branch L_disp
L_ev1:
    s_mov_b64 exec, 0xffff
    buffer_load_dword v48, v49, s[20:23], s36 offen
    s_mov_b64 exec, -1
L_ev1b:
    s_mov_b32 s42, s40
    s_mov_b32 s35, 2
    s_sub_u32 s34, s13, 1
    s_branch L_disp
L_ev2:
    s_waitcnt vmcnt(8)
    s_movk_i32 s45, 2000
    v_sub_u32 v48, s42, v48
    v_cmp_gt_u32 vcc, s45, v48
    s_nop 1
    v_cndmask_b32 v48, 0, v48, vcc
    s_nop 1
    v_add_u32_dpp v48, v48, v48 row_ror:8 row_mask:0xf bank_mask:0xf
    s_nop 1
    v_add_u32_dpp v48, v48, v48 row_ror:4 row_mask:0xf bank_mask:0xf
    s_nop 1
    v_add_u32_dpp v48, v48, v48 row_ror:2 row_mask:0xf bank_mask:0xf
    s_nop 1
    v_add_u32_dpp v48, v48, v48 row_ror:1 row_mask:0xf bank_mask:0xf
    s_nop 0
    v_readfirstlane_b32 s44, v48
    s_nop 0
    s_lshr_b32 s44, s44, 4
    s_sub_u32 s44, s42, s44
    s_sub_u32 s46, s44, s49
    s_lshr_b32 s45, s46, 7
    s_sub_u32 s46, s46, s45
    s_cmp_eq_u32 s48, 0
    s_cselect_b32 s48, s46, s48
    s_min_u32 s48, s48, s46
    s_cmp_eq_u32 s32, 0
    s_cselect_b32 s48, 0, s48
    s_mov_b32 s32, 1
    s_mov_b32 s49, s44
    s_lshl_b32 s47, s44, 3
    s_mul_i32 s45, s48, 5
    s_add_u32 s47, s47, s45
    s_add_u32 s36, s36, 16384
    s_mov_b32 s35, 0
    s_sub_u32 s34, s13, 3
    s_cmp_lt_i32 s34, 8
    s_cselect_b32 s34, 0, s34
    s_branch L_disp
L_lastv:
    v_add_f32_dpp v18, v18, v18 row_ror:8 row_mask:0xf bank_mask:0xf
    s_nop 1
    v_add_f32_dpp v18, v18, v18 row_ror:4 row_mask:0xf bank_mask:0xf
    s_nop 1
    v_add_f32_dpp v18, v18, v18 row_ror:2 row_mask:0xf bank_mask:0xf
    v_mov_b32 v36, v18
    s_nop 1
    v_permlane16_swap_b32 v18, v36
    v_add_f32 v18, v18, v36
    v_mov_b32 v36, v18
    s_nop 1
    v_permlane32_swap_b32 v18, v36
    v_add_f32 v18, v18, v36
    ds_write_b32 v56, v18 offset:6160
    s_branch L_v_f
L_wfin:
    ds_write_b128 v2, v[12:15] offset:2048
    s_waitcnt lgkmcnt(0)
    s_barrier
    s_endpgm
L_extra:
    s_sub_u32 s19, s19, 1
    s_cmp_gt_u32 s19, 4
    s_cbranch_scc1 L_ex1
    v_dot2_f32_bf16 v20, v96, v4, 0
    v_dot2_f32_bf16 v20, v97, v5, v20
    v_dot2_f32_bf16 v20, v98, v6, v20
    v_dot2_f32_bf16 v20, v99, v7, v20
    v_dot2_f32_bf16 v21, v100, v4, 0
    v_dot2_f32_bf16 v21, v101, v5, v21
    v_dot2_f32_bf16 v21, v102, v6, v21
    v_dot2_f32_bf16 v21, v103, v7, v21
    v_dot2_f32_bf16 v22, v104, v4, 0
    v_dot2_f32_bf16 v22, v105, v5, v22
    v_dot2_f32_bf16 v22, v106, v6, v22
    v_dot2_f32_bf16 v22, v107, v7, v22
    v_dot2_f32_bf16 v23, v108, v4, 0
    v_dot2_f32_bf16 v23, v109, v5, v23
    v_dot2_f32_bf16 v23, v110, v6, v23
    v_dot2_f32_bf16 v23, v111, v7, v23
    v_dot2_f32_bf16 v24, v112, v4, 0
    v_dot2_f32_bf16 v24, v113, v5, v24
    v_dot2_f32_bf16 v24, v114, v6, v24
    v_dot2_f32_bf16 v24, v115, v7, v24
    v_add_f32_dpp v28, v20, v20 row_ror:8 row_mask:0xf bank_mask:0xf
    v_add_f32_dpp v29, v21, v21 row_ror:8 row_mask:0xf bank_mask:0xf
    s_nop 0
    v_add_f32_dpp v28, v22, v22 row_ror:8 row_mask:0xf bank_mask:0xc
    v_add_f32_dpp v29, v23, v23 row_ror:8 row_mask:0xf bank_mask:0xc
    s_nop 0
    v_add_f32_dpp v30, v28, v28 row_half_mirror row_mask:0xf bank_mask:0xf
    s_nop 1
    v_add_f32_dpp v30, v29, v29 row_half_mirror row_mask:0xf bank_mask:0xa
    s_nop 1
    v_add_f32_dpp v30, v30, v30 quad_perm:[2,3,0,1] row_mask:0xf bank_mask:0xf
    v_dot2_f32_bf16 v25, v116, v4, 0
    v_dot2_f32_bf16 v25, v117, v5, v25
    v_dot2_f32_bf16 v25, v118, v6, v25
    v_dot2_f32_bf16 v25, v119, v7, v25
    v_dot2_f32_bf16 v26, v120, v4, 0
    v_dot2_f32_bf16 v26, v121, v5, v26
    v_dot2_f32_bf16 v26, v122, v6, v26
    v_dot2_f32_bf16 v26, v123, v7, v26
    v_dot2_f32_bf16 v27, v124, v4, 0
    v_dot2_f32_bf16 v27, v125, v5, v27
    v_dot2_f32_bf16 v27, v126, v6, v27
    v_dot2_f32_bf16 v27, v127, v7, v27
    v_add_f32_dpp v28, v24, v24 row_ror:8 row_mask:0xf bank_mask:0xf
    v_add_f32_dpp v29, v25, v25 row_ror:8 row_mask:0xf bank_mask:0xf
    s_nop 0
    v_add_f32_dpp v28, v26, v26 row_ror:8 row_mask:0xf bank_mask:0xc
    v_add_f32_dpp v29, v27, v27 row_ror:8 row_mask:0xf bank_mask:0xc
    s_nop 0
    v_add_f32_dpp v31, v28, v28 row_half_mirror row_mask:0xf bank_mask:0xf
    s_nop 1
    v_add_f32_dpp v31, v29, v29 row_half_mirror row_mask:0xf bank_mask:0xa
    s_nop 1
    v_add_f32_dpp v31, v31, v31 quad_perm:[2,3,0,1] row_mask:0xf bank_mask:0xf
    v_cndmask_b32 v30, v30, v31, s[90:91]
    s_nop 1
    v_add_f32_dpp v30, v30, v30 quad_perm:[1,0,3,2] row_mask:0xf bank_mask:0xf
    v_cvt_pk_bf16_f32 v30, v30, v30
    v_and_b32 v30, s14, v30
    v_mul_f32 v30, s15, v30
    v_cvt_pk_bf16_f32 v30, v30, v30
    v_and_b32 v30, s14, v30
    ds_write_b32 v54, v30 offset:0
    v_max_f32 v17, v17, v30
    s_cmp_eq_u32 s19, 4
    s_cselect_b32 s59, 5, 1
    s_lshl_b32 s59, s59, 7
    v_add_u32 v54, s59, v54
    s_cmp_eq_u32 s19, 0
    s_cbranch_scc1 L_k_n
    ds_read_b128 v[96:99], v58 offset:0
    ds_read_b128 v[100:103], v58 offset:1024
    ds_read_b128 v[104:107], v58 offset:2048
    ds_read_b128 v[108:111], v58 offset:3072
    ds_read_b128 v[112:115], v58 offset:4096
    ds_read_b128 v[116:119], v58 offset:5120
    ds_read_b128 v[120:123], v58 offset:6144
    ds_read_b128 v[124:127], v58 offset:7168
    v_add_u32 v58, 0x2000, v58
    s_branch L_k_f
L_ex1:
    s_cmp_lg_u32 s19, 5
    s_cbranch_scc1 L_ex2
    v_dot2_f32_bf16 v20, v128, v4, 0
    v_dot2_f32_bf16 v20, v129, v5, v20
    v_dot2_f32_bf16 v20, v130, v6, v20
    v_dot2_f32_bf16 v20, v131, v7, v20
    v_dot2_f32_bf16 v21, v132, v4, 0
    v_dot2_f32_bf16 v21, v133, v5, v21
    v_dot2_f32_bf16 v21, v134, v6, v21
    v_dot2_f32_bf16 v21, v135, v7, v21
    v_dot2_f32_bf16 v22, v136, v4, 0
    v_dot2_f32_bf16 v22, v137, v5, v22
    v_dot2_f32_bf16 v22, v138, v6, v22
    v_dot2_f32_bf16 v22, v139, v7, v22
    v_dot2_f32_bf16 v23, v140, v4, 0
    v_dot2_f32_bf16 v23, v141, v5, v23
    v_dot2_f32_bf16 v23, v142, v6, v23
    v_dot2_f32_bf16 v23, v143, v7, v23
    v_dot2_f32_bf16 v24, v144, v4, 0
    v_dot2_f32_bf16 v24, v145, v5, v24
    v_dot2_f32_bf16 v24, v146, v6, v24
    v_dot2_f32_bf16 v24, v147, v7, v24
    v_add_f32_dpp v28, v20, v20 row_ror:8 row_mask:0xf bank_mask:0xf
    v_add_f32_dpp v29, v21, v21 row_ror:8 row_mask:0xf bank_mask:0xf
    s_nop 0
    v_add_f32_dpp v28, v22, v22 row_ror:8 row_mask:0xf bank_mask:0xc
    v_add_f32_dpp v29, v23, v23 row_ror:8 row_mask:0xf bank_mask:0xc
    s_nop 0
    v_add_f32_dpp v30, v28, v28 row_half_mirror row_mask:0xf bank_mask:0xf
    s_nop 1
    v_add_f32_dpp v30, v29, v29 row_half_mirror row_mask:0xf bank_mask:0xa
    s_nop 1
    v_add_f32_dpp v30, v30, v30 quad_perm:[2,3,0,1] row_mask:0xf bank_mask:0xf
    v_dot2_f32_bf16 v25, v148, v4, 0
    v_dot2_f32_bf16 v25, v149, v5, v25
    v_dot2_f32_bf16 v25, v150, v6, v25
    v_dot2_f32_bf16 v25, v151, v7, v25
    v_dot2_f32_bf16 v26, v152, v4, 0
    v_dot2_f32_bf16 v26, v153, v5, v26
    v_dot2_f32_bf16 v26, v154, v6, v26
    v_dot2_f32_bf16 v26, v155, v7, v26
    v_dot2_f32_bf16 v27, v156, v4, 0
    v_dot2_f32_bf16 v27, v157, v5, v27
    v_dot2_f32_bf16 v27, v158, v6, v27
    v_dot2_f32_bf16 v27, v159, v7, v27
    v_add_f32_dpp v28, v24, v24 row_ror:8 row_mask:0xf bank_mask:0xf
    v_add_f32_dpp v29, v25, v25 row_ror:8 row_mask:0xf bank_mask:0xf
    s_nop 0
    v_add_f32_dpp v28, v26, v26 row_ror:8 row_mask:0xf bank_mask:0xc
    v_add_f32_dpp v29, v27, v27 row_ror:8 row_mask:0xf bank_mask:0xc
    s_nop 0
    v_add_f32_dpp v31, v28, v28 row_half_mirror row_mask:0xf bank_mask:0xf
    s_nop 1
    v_add_f32_dpp v31, v29, v29 row_half_mirror row_mask:0xf bank_mask:0xa
    s_nop 1
    v_add_f32_dpp v31, v31, v31 quad_perm:[2,3,0,1] row_mask:0xf bank_mask:0xf
    v_cndmask_b32 v30, v30, v31, s[90:91]
    s_nop 1
    v_add_f32_dpp v30, v30, v30 quad_perm:[1,0,3,2] row_mask:0xf bank_mask:0xf
    v_cvt_pk_bf16_f32 v30, v30, v30
    v_and_b32 v30, s14, v30
    v_mul_f32 v30, s15, v30
    v_cvt_pk_bf16_f32 v30, v30, v30
    v_and_b32 v30, s14, v30
    ds_write_b32 v52, v30 offset:128
    v_max_f32 v17, v17, v30
    s_branch L_k_f
L_ex2:
    s_cmp_lg_u32 s19, 6
    s_cbranch_scc1 L_ex3
    v_dot2_f32_bf16 v20, v160, v4, 0
    v_dot2_f32_bf16 v20, v161, v5, v20
    v_dot2_f32_bf16 v20, v162, v6, v20
    v_dot2_f32_bf16 v20, v163, v7, v20
    v_dot2_f32_bf16 v21, v164, v4, 0
    v_dot2_f32_bf16 v21, v165, v5, v21
    v_dot2_f32_bf16 v21, v166, v6, v21
    v_dot2_f32_bf16 v21, v167, v7, v21
    v_dot2_f32_bf16 v22, v168, v4, 0
    v_dot2_f32_bf16 v22, v169, v5, v22
    v_dot2_f32_bf16 v22, v170, v6, v22
    v_dot2_f32_bf16 v22, v171, v7, v22
    v_dot2_f32_bf16 v23, v172, v4, 0
    v_dot2_f32_bf16 v23, v173, v5, v23
    v_dot2_f32_bf16 v23, v174, v6, v23
    v_dot2_f32_bf16 v23, v175, v7, v23
    v_dot2_f32_bf16 v24, v176, v4, 0
    v_dot2_f32_bf16 v24, v177, v5, v24
    v_dot2_f32_bf16 v24, v178, v6, v24
    v_dot2_f32_bf16 v24, v179, v7, v24
    v_add_f32_dpp v28, v20, v20 row_ror:8 row_mask:0xf bank_mask:0xf
    v_add_f32_dpp v29, v21, v21 row_ror:8 row_mask:0xf bank_mask:0xf
    s_nop 0
    v_add_f32_dpp v28, v22, v22 row_ror:8 row_mask:0xf bank_mask:0xc
    v_add_f32_dpp v29, v23, v23 row_ror:8 row_mask:0xf bank_mask:0xc
    s_nop 0
    v_add_f32_dpp v30, v28, v28 row_half_mirror row_mask:0xf bank_mask:0xf
    s_nop 1
    v_add_f32_dpp v30, v29, v29 row_half_mirror row_mask:0xf bank_mask:0xa
    s_nop 1
    v_add_f32_dpp v30, v30, v30 quad_perm:[2,3,0,1] row_mask:0xf bank_mask:0xf
    v_dot2_f32_bf16 v25, v180, v4, 0
    v_dot2_f32_bf16 v25, v181, v5, v25
    v_dot2_f32_bf16 v25, v182, v6, v25
    v_dot2_f32_bf16 v25, v183, v7, v25
    v_dot2_f32_bf16 v26, v184, v4, 0
    v_dot2_f32_bf16 v26, v185, v5, v26
    v_dot2_f32_bf16 v26, v186, v6, v26
    v_dot2_f32_bf16 v26, v187, v7, v26
    v_dot2_f32_bf16 v27, v188, v4, 0
    v_dot2_f32_bf16 v27, v189, v5, v27
    v_dot2_f32_bf16 v27, v190, v6, v27
    v_dot2_f32_bf16 v27, v191, v7, v27
    v_add_f32_dpp v28, v24, v24 row_ror:8 row_mask:0xf bank_mask:0xf
    v_add_f32_dpp v29, v25, v25 row_ror:8 row_mask:0xf bank_mask:0xf
    s_nop 0
    v_add_f32_dpp v28, v26, v26 row_ror:8 row_mask:0xf bank_mask:0xc
    v_add_f32_dpp v29, v27, v27 row_ror:8 row_mask:0xf bank_mask:0xc
    s_nop 0
    v_add_f32_dpp v31, v28, v28 row_half_mirror row_mask:0xf bank_mask:0xf
    s_nop 1
    v_add_f32_dpp v31, v29, v29 row_half_mirror row_mask:0xf bank_mask:0xa
    s_nop 1
    v_add_f32_dpp v31, v31, v31 quad_perm:[2,3,0,1] row_mask:0xf bank_mask:0xf
    v_cndmask_b32 v30, v30, v31, s[90:91]
    s_nop 1
    v_add_f32_dpp v30, v30, v30 quad_perm:[1,0,3,2] row_mask:0xf bank_mask:0xf
    v_cvt_pk_bf16_f32 v30, v30, v30
    v_and_b32 v30, s14, v30
    v_mul_f32 v30, s15, v30
    v_cvt_pk_bf16_f32 v30, v30, v30
    v_and_b32 v30, s14, v30
    ds_write_b32 v52, v30 offset:256
    v_max_f32 v17, v17, v30
    s_branch L_k_f
L_ex3:
    s_cmp_lg_u32 s19, 7
    s_cbranch_scc1 L_ex4
    v_dot2_f32_bf16 v20, v192, v4, 0
    v_dot2_f32_bf16 v20, v193, v5, v20
    v_dot2_f32_bf16 v20, v194, v6, v20
    v_dot2_f32_bf16 v20, v195, v7, v20
    v_dot2_f32_bf16 v21, v196, v4, 0
    v_dot2_f32_bf16 v21, v197, v5, v21
    v_dot2_f32_bf16 v21, v198, v6, v21
    v_dot2_f32_bf16 v21, v199, v7, v21
    v_dot2_f32_bf16 v22, v200, v4, 0
    v_dot2_f32_bf16 v22, v201, v5, v22
    v_dot2_f32_bf16 v22, v202, v6, v22
    v_dot2_f32_bf16 v22, v203, v7, v22
    v_dot2_f32_bf16 v23, v204, v4, 0
    v_dot2_f32_bf16 v23, v205, v5, v23
    v_dot2_f32_bf16 v23, v206, v6, v23
    v_dot2_f32_bf16 v23, v207, v7, v23
    v_dot2_f32_bf16 v24, v208, v4, 0
    v_dot2_f32_bf16 v24, v209, v5, v24
    v_dot2_f32_bf16 v24, v210, v6, v24
    v_dot2_f32_bf16 v24, v211, v7, v24
    v_add_f32_dpp v28, v20, v20 row_ror:8 row_mask:0xf bank_mask:0xf
    v_add_f32_dpp v29, v21, v21 row_ror:8 row_mask:0xf bank_mask:0xf
    s_nop 0
    v_add_f32_dpp v28, v22, v22 row_ror:8 row_mask:0xf bank_mask:0xc
    v_add_f32_dpp v29, v23, v23 row_ror:8 row_mask:0xf bank_mask:0xc
    s_nop 0
    v_add_f32_dpp v30, v28, v28 row_half_mirror row_mask:0xf bank_mask:0xf
    s_nop 1
    v_add_f32_dpp v30, v29, v29 row_half_mirror row_mask:0xf bank_mask:0xa
    s_nop 1
    v_add_f32_dpp v30, v30, v30 quad_perm:[2,3,0,1] row_mask:0xf bank_mask:0xf
    v_dot2_f32_bf16 v25, v212, v4, 0
    v_dot2_f32_bf16 v25, v213, v5, v25
    v_dot2_f32_bf16 v25, v214, v6, v25
    v_dot2_f32_bf16 v25, v215, v7, v25
    v_dot2_f32_bf16 v26, v216, v4, 0
    v_dot2_f32_bf16 v26, v217, v5, v26
    v_dot2_f32_bf16 v26, v218, v6, v26
    v_dot2_f32_bf16 v26, v219, v7, v26
    v_dot2_f32_bf16 v27, v220, v4, 0
    v_dot2_f32_bf16 v27, v221, v5, v27
    v_dot2_f32_bf16 v27, v222, v6, v27
    v_dot2_f32_bf16 v27, v223, v7, v27
    v_add_f32_dpp v28, v24, v24 row_ror:8 row_mask:0xf bank_mask:0xf
    v_add_f32_dpp v29, v25, v25 row_ror:8 row_mask:0xf bank_mask:0xf
    s_nop 0
    v_add_f32_dpp v28, v26, v26 row_ror:8 row_mask:0xf bank_mask:0xc
    v_add_f32_dpp v29, v27, v27 row_ror:8 row_mask:0xf bank_mask:0xc
    s_nop 0
    v_add_f32_dpp v31, v28, v28 row_half_mirror row_mask:0xf bank_mask:0xf
    s_nop 1
    v_add_f32_dpp v31, v29, v29 row_half_mirror row_mask:0xf bank_mask:0xa
    s_nop 1
    v_add_f32_dpp v31, v31, v31 quad_perm:[2,3,0,1] row_mask:0xf bank_mask:0xf
    v_cndmask_b32 v30, v30, v31, s[90:91]
    s_nop 1
    v_add_f32_dpp v30, v30, v30 quad_perm:[1,0,3,2] row_mask:0xf bank_mask:0xf
    v_cvt_pk_bf16_f32 v30, v30, v30
    v_and_b32 v30, s14, v30
    v_mul_f32 v30, s15, v30
    v_cvt_pk_bf16_f32 v30, v30, v30
    v_and_b32 v30, s14, v30
    ds_write_b32 v52, v30 offset:384
    v_max_f32 v17, v17, v30
    s_branch L_k_f
L_ex4:
    v_dot2_f32_bf16 v20, v224, v4, 0
    v_dot2_f32_bf16 v20, v225, v5, v20
    v_dot2_f32_bf16 v20, v226, v6, v20
    v_dot2_f32_bf16 v20, v227, v7, v20
    v_dot2_f32_bf16 v21, v228, v4, 0
    v_dot2_f32_bf16 v21, v229, v5, v21
    v_dot2_f32_bf16 v21, v230, v6, v21
    v_dot2_f32_bf16 v21, v231, v7, v21
    v_dot2_f32_bf16 v22, v232, v4, 0
    v_dot2_f32_bf16 v22, v233, v5, v22
    v_dot2_f32_bf16 v22, v234, v6, v22
    v_dot2_f32_bf16 v22, v235, v7, v22
    v_dot2_f32_bf16 v23, v236, v4, 0
    v_dot2_f32_bf16 v23, v237, v5, v23
    v_dot2_f32_bf16 v23, v238, v6, v23
    v_dot2_f32_bf16 v23, v239, v7, v23
    v_dot2_f32_bf16 v24, v240, v4, 0
    v_dot2_f32_bf16 v24, v241, v5, v24
    v_dot2_f32_bf16 v24, v242, v6, v24
    v_dot2_f32_bf16 v24, v243, v7, v24
    v_add_f32_dpp v28, v20, v20 row_ror:8 row_mask:0xf bank_mask:0xf
    v_add_f32_dpp v29, v21, v21 row_ror:8 row_mask:0xf bank_mask:0xf
    s_nop 0
    v_add_f32_dpp v28, v22, v22 row_ror:8 row_mask:0xf bank_mask:0xc
    v_add_f32_dpp v29, v23, v23 row_ror:8 row_mask:0xf bank_mask:0xc
    s_nop 0
    v_add_f32_dpp v30, v28, v28 row_half_mirror row_mask:0xf bank_mask:0xf
    s_nop 1
    v_add_f32_dpp v30, v29, v29 row_half_mirror row_mask:0xf bank_mask:0xa
    s_nop 1
    v_add_f32_dpp v30, v30, v30 quad_perm:[2,3,0,1] row_mask:0xf bank_mask:0xf
    v_dot2_f32_bf16 v25, v244, v4, 0
    v_dot2_f32_bf16 v25, v245, v5, v25
    v_dot2_f32_bf16 v25, v246, v6, v25
    v_dot2_f32_bf16 v25, v247, v7, v25
    v_dot2_f32_bf16 v26, v248, v4, 0
    v_dot2_f32_bf16 v26, v249, v5, v26
    v_dot2_f32_bf16 v26, v250, v6, v26
    v_dot2_f32_bf16 v26, v251, v7, v26
    v_dot2_f32_bf16 v27, v252, v4, 0
    v_dot2_f32_bf16 v27, v253, v5, v27
    v_dot2_f32_bf16 v27, v254, v6, v27
    v_dot2_f32_bf16 v27, v255, v7, v27
    v_add_f32_dpp v28, v24, v24 row_ror:8 row_mask:0xf bank_mask:0xf
    v_add_f32_dpp v29, v25, v25 row_ror:8 row_mask:0xf bank_mask:0xf
    s_nop 0
    v_add_f32_dpp v28, v26, v26 row_ror:8 row_mask:0xf bank_mask:0xc
    v_add_f32_dpp v29, v27, v27 row_ror:8 row_mask:0xf bank_mask:0xc
    s_nop 0
    v_add_f32_dpp v31, v28, v28 row_half_mirror row_mask:0xf bank_mask:0xf
    s_nop 1
    v_add_f32_dpp v31, v29, v29 row_half_mirror row_mask:0xf bank_mask:0xa
    s_nop 1
    v_add_f32_dpp v31, v31, v31 quad_perm:[2,3,0,1] row_mask:0xf bank_mask:0xf
    v_cndmask_b32 v30, v30, v31, s[90:91]
    s_nop 1
    v_add_f32_dpp v30, v30, v30 quad_perm:[1,0,3,2] row_mask:0xf bank_mask:0xf
    v_cvt_pk_bf16_f32 v30, v30, v30
    v_and_b32 v30, s14, v30
    v_mul_f32 v30, s15, v30
    v_cvt_pk_bf16_f32 v30, v30, v30
    v_and_b32 v30, s14, v30
    ds_write_b32 v52, v30 offset:512
    v_max_f32 v17, v17, v30
    s_branch L_k_f
L_aux:
    s_sub_u32 s3, s3, 4
    s_lshl_b32 s17, s57, 10
    s_xor_b32 s18, s17, 1024
    v_lshlrev_b32 v4, 2, v3
    s_lshl_b32 s19, s3, 8
    s_add_u32 s28, s19, s18
    s_add_u32 s19, s19, s17
    v_lshrrev_b32 v5, 4, v3
    v_and_b32 v6, 15, v3
    v_lshlrev_b32 v19, 18, v5
    v_lshl_add_u32 v19, v6, 4, v19
    s_lshl_b32 s52, s3, 20
    s_lshl_b32 s53, s58, 8
    s_add_u32 s52, s52, s53
    s_movk_i32 s53, 0x2000
    s_getpc_b64 s[62:63]
L_pc0:
    s_sub_u32 s6, s62, L_pc0-recurrent_scan__mha_block_cached__swiglu_ffn__decode_kernel
    s_subb_u32 s7, s63, 0
    v_lshlrev_b32 v20, 7, v3
    s_lshl_b32 s8, s3, 13
    v_add_u32 v20, s8, v20
    v_min_u32 v20, L_codeend-recurrent_scan__mha_block_cached__swiglu_ffn__decode_kernel-4, v20
    s_cmp_lg_u32 s55, 0
    s_cbranch_scc1 L_nocpf
    s_cmp_gt_u32 s3, 1
    s_cbranch_scc1 L_nocpf
    global_load_dword v21, v20, s[6:7]
L_nocpf:
    s_add_u32 s32, s62, L_gemv-L_pc0
    s_addc_u32 s33, s63, 0
    s_add_u32 s4, s62, L_gemv2-L_pc0
    s_addc_u32 s5, s63, 0
    s_add_u32 s62, s62, L_load32-L_pc0
    s_addc_u32 s63, s63, 0
    s_waitcnt lgkmcnt(0)
    s_mov_b32 s24, s64
    s_mov_b32 s25, s65
    s_mov_b32 s26, 2048
    s_mov_b32 s27, 0x20000
    buffer_load_dwordx4 v[40:43], v1, s[24:27], s17 offen
    buffer_load_dwordx4 v[44:47], v1, s[24:27], s18 offen
    buffer_load_dword v48, v4, s[24:27], s19 offen
    buffer_load_dword v49, v4, s[24:27], s28 offen
    s_add_u32 s44, s86, 1712128
    s_addc_u32 s45, s87, 0
    s_load_dword s46, s[44:45], 0
    s_load_dword s47, s[44:45], 256
    s_mov_b32 s20, s86
    s_mov_b32 s21, s87
    s_mov_b32 s22, 1073741824
    s_mov_b32 s23, 0x20000
    s_mov_b32 s48, s70
    s_mov_b32 s49, s71
    s_mov_b32 s50, 4194304
    s_mov_b32 s51, 0x20000
    buffer_load_dwordx4 v[128:131], v19, s[48:51], s52 offen nt
    s_add_u32 s52, s52, s53
    buffer_load_dwordx4 v[132:135], v19, s[48:51], s52 offen nt
    s_add_u32 s52, s52, s53
    buffer_load_dwordx4 v[136:139], v19, s[48:51], s52 offen nt
    s_add_u32 s52, s52, s53
    buffer_load_dwordx4 v[140:143], v19, s[48:51], s52 offen nt
    s_add_u32 s52, s52, s53
    buffer_load_dwordx4 v[144:147], v19, s[48:51], s52 offen nt
    s_add_u32 s52, s52, s53
    buffer_load_dwordx4 v[148:151], v19, s[48:51], s52 offen nt
    s_add_u32 s52, s52, s53
    buffer_load_dwordx4 v[152:155], v19, s[48:51], s52 offen nt
    s_add_u32 s52, s52, s53
    buffer_load_dwordx4 v[156:159], v19, s[48:51], s52 offen nt
    s_add_u32 s52, s52, s53
    v_and_b32 v2, 7, v3
    v_mov_b32 v36, 0xffff
    v_mov_b32 v37, s14
    v_cmp_eq_u32 s[88:89], 0, v2
    v_cmp_eq_u32 vcc, 1, v2
    s_nop 0
    v_cndmask_b32 v8, 0, v36, s[88:89]
    v_cndmask_b32 v8, v8, v37, vcc
    v_cmp_eq_u32 s[88:89], 2, v2
    v_cmp_eq_u32 vcc, 3, v2
    s_nop 0
    v_cndmask_b32 v9, 0, v36, s[88:89]
    v_cndmask_b32 v9, v9, v37, vcc
    v_cmp_eq_u32 s[88:89], 4, v2
    v_cmp_eq_u32 vcc, 5, v2
    s_nop 0
    v_cndmask_b32 v10, 0, v36, s[88:89]
    v_cndmask_b32 v10, v10, v37, vcc
    v_cmp_eq_u32 s[88:89], 6, v2
    v_cmp_eq_u32 vcc, 7, v2
    s_nop 0
    v_cndmask_b32 v11, 0, v36, s[88:89]
    v_cndmask_b32 v11, v11, v37, vcc
    v_mov_b32 v7, 0
    ds_write_b32 v7, v7 offset:6184
    s_lshl_b32 s59, s3, 2
    v_mov_b32 v39, s59
    v_mov_b32 v7, 0x100
    ds_write_b32 v39, v7 offset:6192
    v_mov_b32 v7, -1
    ds_write_b32 v39, v7 offset:6160
    s_waitcnt vmcnt(8)
    v_lshlrev_b32 v64, 16, v40
    v_and_b32 v65, s14, v40
    v_lshlrev_b32 v66, 16, v41
    v_and_b32 v67, s14, v41
    v_lshlrev_b32 v68, 16, v42
    v_and_b32 v69, s14, v42
    v_lshlrev_b32 v70, 16, v43
    v_and_b32 v71, s14, v43
    v_lshlrev_b32 v72, 16, v44
    v_and_b32 v73, s14, v44
    v_lshlrev_b32 v74, 16, v45
    v_and_b32 v75, s14, v45
    v_lshlrev_b32 v76, 16, v46
    s_waitcnt vmcnt(7)
    buffer_load_dwordx4 v[160:163], v19, s[48:51], s52 offen nt
    s_add_u32 s52, s52, s53
    v_and_b32 v77, s14, v46
    v_lshlrev_b32 v78, 16, v47
    v_and_b32 v79, s14, v47
    v_add_f32 v50, v64, v65
    v_add_f32 v51, v72, v73
    v_add_f32 v50, v50, v66
    v_add_f32 v51, v51, v74
    v_add_f32 v50, v50, v67
    v_add_f32 v51, v51, v75
    v_add_f32 v50, v50, v68
    v_add_f32 v51, v51, v76
    v_add_f32 v50, v50, v69
    v_add_f32 v51, v51, v77
    s_waitcnt vmcnt(7)
    buffer_load_dwordx4 v[164:167], v19, s[48:51], s52 offen nt
    s_add_u32 s52, s52, s53
    v_add_f32 v50, v50, v70
    v_add_f32 v51, v51, v78
    v_add_f32 v50, v50, v71
    v_add_f32 v51, v51, v79
    s_nop 0
    v_add_f32_dpp v50, v50, v50 row_ror:8 row_mask:0xf bank_mask:0xf
    v_add_f32_dpp v51, v51, v51 row_ror:8 row_mask:0xf bank_mask:0xf
    s_nop 0
    v_add_f32_dpp v50, v50, v50 row_ror:4 row_mask:0xf bank_mask:0xf
    v_add_f32_dpp v51, v51, v51 row_ror:4 row_mask:0xf bank_mask:0xf
    s_nop 0
    v_add_f32_dpp v50, v50, v50 row_ror:2 row_mask:0xf bank_mask:0xf
    v_add_f32_dpp v51, v51, v51 row_ror:2 row_mask:0xf bank_mask:0xf
    s_nop 0
    v_add_f32_dpp v50, v50, v50 row_ror:1 row_mask:0xf bank_mask:0xf
    v_add_f32_dpp v51, v51, v51 row_ror:1 row_mask:0xf bank_mask:0xf
    v_mov_b32 v52, v50
    s_waitcnt vmcnt(7)
    buffer_load_dwordx4 v[168:171], v19, s[48:51], s52 offen nt
    s_add_u32 s52, s52, s53
    v_mov_b32 v53, v51
    v_permlane16_swap_b32 v50, v52
    s_nop 0
    v_permlane16_swap_b32 v51, v53
    v_add_f32 v50, v50, v52
    v_add_f32 v51, v51, v53
    v_mov_b32 v52, v50
    v_mov_b32 v53, v51
    s_nop 0
    v_permlane32_swap_b32 v50, v52
    v_permlane32_swap_b32 v51, v53
    v_add_f32 v50, v50, v52
    v_add_f32 v51, v51, v53
    s_mov_b32 s59, 0x3b000000
    v_mul_f32 v50, s59, v50
    s_waitcnt vmcnt(7)
    buffer_load_dwordx4 v[172:175], v19, s[48:51], s52 offen nt
    s_add_u32 s52, s52, s53
    v_mul_f32 v51, s59, v51
    v_sub_f32 v64, v64, v50
    v_sub_f32 v72, v72, v51
    v_sub_f32 v65, v65, v50
    v_sub_f32 v73, v73, v51
    v_sub_f32 v66, v66, v50
    v_sub_f32 v74, v74, v51
    v_sub_f32 v67, v67, v50
    v_sub_f32 v75, v75, v51
    v_sub_f32 v68, v68, v50
    v_sub_f32 v76, v76, v51
    v_sub_f32 v69, v69, v50
    v_sub_f32 v77, v77, v51
    s_waitcnt vmcnt(7)
    buffer_load_dwordx4 v[176:179], v19, s[48:51], s52 offen nt
    s_add_u32 s52, s52, s53
    v_sub_f32 v70, v70, v50
    v_sub_f32 v78, v78, v51
    v_sub_f32 v71, v71, v50
    v_sub_f32 v79, v79, v51
    v_mul_f32 v54, v64, v64
    v_mul_f32 v55, v72, v72
    v_fmac_f32 v54, v65, v65
    v_fmac_f32 v55, v73, v73
    v_fmac_f32 v54, v66, v66
    v_fmac_f32 v55, v74, v74
    v_fmac_f32 v54, v67, v67
    v_fmac_f32 v55, v75, v75
    v_fmac_f32 v54, v68, v68
    s_waitcnt vmcnt(7)
    buffer_load_dwordx4 v[180:183], v19, s[48:51], s52 offen nt
    s_add_u32 s52, s52, s53
    v_fmac_f32 v55, v76, v76
    v_fmac_f32 v54, v69, v69
    v_fmac_f32 v55, v77, v77
    v_fmac_f32 v54, v70, v70
    v_fmac_f32 v55, v78, v78
    v_fmac_f32 v54, v71, v71
    v_fmac_f32 v55, v79, v79
    s_nop 0
    v_add_f32_dpp v54, v54, v54 row_ror:8 row_mask:0xf bank_mask:0xf
    v_add_f32_dpp v55, v55, v55 row_ror:8 row_mask:0xf bank_mask:0xf
    s_nop 0
    v_add_f32_dpp v54, v54, v54 row_ror:4 row_mask:0xf bank_mask:0xf
    v_add_f32_dpp v55, v55, v55 row_ror:4 row_mask:0xf bank_mask:0xf
    s_nop 0
    v_add_f32_dpp v54, v54, v54 row_ror:2 row_mask:0xf bank_mask:0xf
    v_add_f32_dpp v55, v55, v55 row_ror:2 row_mask:0xf bank_mask:0xf
    s_waitcnt vmcnt(7)
    buffer_load_dwordx4 v[184:187], v19, s[48:51], s52 offen nt
    s_add_u32 s52, s52, s53
    v_add_f32_dpp v54, v54, v54 row_ror:1 row_mask:0xf bank_mask:0xf
    v_add_f32_dpp v55, v55, v55 row_ror:1 row_mask:0xf bank_mask:0xf
    v_mov_b32 v52, v54
    v_mov_b32 v53, v55
    s_nop 0
    v_permlane16_swap_b32 v54, v52
    v_permlane16_swap_b32 v55, v53
    v_add_f32 v54, v54, v52
    v_add_f32 v55, v55, v53
    v_mov_b32 v52, v54
    v_mov_b32 v53, v55
    s_nop 0
    v_permlane32_swap_b32 v54, v52
    v_permlane32_swap_b32 v55, v53
    v_add_f32 v54, v54, v52
    s_waitcnt vmcnt(7)
    buffer_load_dwordx4 v[188:191], v19, s[48:51], s52 offen nt
    s_add_u32 s52, s52, s53
    v_add_f32 v55, v55, v53
    s_mov_b32 s88, 0x3727c5ac
    v_mul_f32 v54, s59, v54
    v_mul_f32 v55, s59, v55
    v_cvt_pk_bf16_f32 v54, v54, v54
    v_cvt_pk_bf16_f32 v55, v55, v55
    v_cvt_pk_bf16_f32 v50, v50, v50
    v_cvt_pk_bf16_f32 v51, v51, v51
    v_and_b32 v54, s14, v54
    v_and_b32 v55, s14, v55
    v_and_b32 v50, s14, v50
    v_and_b32 v51, s14, v51
    v_add_f32 v54, s88, v54
    s_waitcnt vmcnt(7)
    buffer_load_dwordx4 v[192:195], v19, s[48:51], s52 offen nt
    s_add_u32 s52, s52, s53
    v_add_f32 v55, s88, v55
    v_cvt_pk_bf16_f32 v54, v54, v54
    v_cvt_pk_bf16_f32 v55, v55, v55
    v_and_b32 v54, s14, v54
    v_and_b32 v55, s14, v55
    v_sqrt_f32 v54, v54
    v_sqrt_f32 v55, v55
    v_lshlrev_b32 v26, 16, v48
    v_and_b32 v27, s14, v48
    v_lshlrev_b32 v22, 16, v49
    v_and_b32 v23, s14, v49
    v_cvt_pk_bf16_f32 v54, v54, v54
    v_cvt_pk_bf16_f32 v55, v55, v55
    s_waitcnt vmcnt(7)
    buffer_load_dwordx4 v[196:199], v19, s[48:51], s52 offen nt
    s_add_u32 s52, s52, s53
    v_and_b32 v54, s14, v54
    v_and_b32 v55, s14, v55
    v_rcp_f32 v54, v54
    v_rcp_f32 v55, v55
    v_sub_f32 v26, v26, v50
    v_sub_f32 v27, v27, v50
    v_sub_f32 v22, v22, v51
    v_sub_f32 v23, v23, v51
    v_cvt_pk_bf16_f32 v26, v26, v26
    v_cvt_pk_bf16_f32 v27, v27, v27
    v_cvt_pk_bf16_f32 v22, v22, v22
    v_cvt_pk_bf16_f32 v23, v23, v23
    v_and_b32 v26, s14, v26
    s_waitcnt vmcnt(7)
    buffer_load_dwordx4 v[200:203], v19, s[48:51], s52 offen nt
    s_add_u32 s52, s52, s53
    v_and_b32 v27, s14, v27
    v_and_b32 v22, s14, v22
    v_and_b32 v23, s14, v23
    v_mul_f32 v26, v26, v54
    v_mul_f32 v27, v27, v54
    v_mul_f32 v22, v22, v55
    v_mul_f32 v23, v23, v55
    v_cvt_pk_bf16_f32 v26, v26, v26
    v_cvt_pk_bf16_f32 v27, v27, v27
    v_cvt_pk_bf16_f32 v22, v22, v22
    v_cvt_pk_bf16_f32 v23, v23, v23
    s_lshl_b32 s59, s3, 9
    v_lshlrev_b32 v7, 7, v5
    s_waitcnt vmcnt(7)
    buffer_load_dwordx4 v[204:207], v19, s[48:51], s52 offen nt
    s_add_u32 s52, s52, s53
    v_lshl_add_u32 v7, v6, 2, v7
    v_add_u32 v7, s59, v7
    s_mov_b32 s90, 0x00ff00ff
    s_mov_b32 s91, 0x00ff00ff
    s_waitcnt vmcnt(7)
    buffer_load_dwordx4 v[208:211], v19, s[48:51], s52 offen nt
    s_add_u32 s52, s52, s53
    s_waitcnt vmcnt(7)
    buffer_load_dwordx4 v[212:215], v19, s[48:51], s52 offen nt
    s_add_u32 s52, s52, s53
    s_waitcnt vmcnt(7)
    buffer_load_dwordx4 v[216:219], v19, s[48:51], s52 offen nt
    s_add_u32 s52, s52, s53
    s_waitcnt vmcnt(7)
    buffer_load_dwordx4 v[220:223], v19, s[48:51], s52 offen nt
    s_add_u32 s52, s52, s53
    s_waitcnt vmcnt(7)
    buffer_load_dwordx4 v[224:227], v19, s[48:51], s52 offen nt
    s_add_u32 s52, s52, s53
    s_waitcnt vmcnt(7)
    buffer_load_dwordx4 v[228:231], v19, s[48:51], s52 offen nt
    s_add_u32 s52, s52, s53
    s_waitcnt vmcnt(7)
    buffer_load_dwordx4 v[232:235], v19, s[48:51], s52 offen nt
    s_add_u32 s52, s52, s53
    s_waitcnt vmcnt(7)
    buffer_load_dwordx4 v[236:239], v19, s[48:51], s52 offen nt
    s_add_u32 s52, s52, s53
    s_waitcnt vmcnt(7)
    buffer_load_dwordx4 v[240:243], v19, s[48:51], s52 offen nt
    s_add_u32 s52, s52, s53
    s_waitcnt vmcnt(7)
    buffer_load_dwordx4 v[244:247], v19, s[48:51], s52 offen nt
    s_add_u32 s52, s52, s53
    s_waitcnt vmcnt(7)
    buffer_load_dwordx4 v[248:251], v19, s[48:51], s52 offen nt
    s_add_u32 s52, s52, s53
    s_waitcnt vmcnt(7)
    buffer_load_dwordx4 v[252:255], v19, s[48:51], s52 offen nt
    s_swappc_b64 s[60:61], s[32:33]
    s_mov_b64 exec, s[90:91]
    ds_write_b32 v7, v12 offset:0
    ds_write_b32 v7, v13 offset:32
    ds_write_b32 v7, v14 offset:64
    ds_write_b32 v7, v15 offset:96
    s_mov_b64 exec, -1
    s_waitcnt lgkmcnt(0)
    s_barrier
    s_add_u32 s46, s46, 1
    s_and_b32 s46, s46, 0xff
    s_add_u32 s47, s47, 1
    s_and_b32 s47, s47, 0xff
    s_cmp_eq_u32 s57, 0
    s_cselect_b32 s59, s46, s47
    s_cselect_b32 s47, s47, s46
    v_mov_b32 v16, 0xff
    v_mov_b32 v124, s59
    v_add_u32 v125, 0x5b, v124
    v_add_u32 v126, 0xc2, v124
    v_add_u32 v127, 0x37, v124
    v_and_b32 v125, v16, v125
    v_and_b32 v126, v16, v126
    v_and_b32 v127, v16, v127
    s_cmp_lg_u32 s56, 0
    s_cbranch_scc1 L_noffn
    s_cmp_ge_u32 s97, 28
    s_cbranch_scc1 L_noffn
    v_mov_b32 v20, v26
    v_mov_b32 v21, v27
    s_mov_b32 s59, 114688
    v_mul_lo_u32 v2, v5, s59
    v_and_b32 v25, 7, v6
    v_lshl_add_u32 v2, v25, 4, v2
    s_mul_i32 s28, s3, 458752
    s_lshl_b32 s29, s97, 7
    s_add_u32 s28, s28, s29
    s_movk_i32 s53, 3584
    s_lshl_b32 s59, s3, 10
    v_lshlrev_b32 v7, 7, v5
    v_lshl_add_u32 v7, v6, 2, v7
    v_add_u32 v7, s59, v7
    s_mov_b32 s88, 0x00ff00ff
    s_mov_b32 s89, 0
    s_waitcnt vmcnt(0)
    s_mov_b32 s48, s76
    s_mov_b32 s49, s77
    s_mov_b32 s50, 1835008
    s_mov_b32 s51, 0x20000
    s_mov_b32 s52, s28
    s_swappc_b64 s[60:61], s[62:63]
    v_mov_b32 v26, v20
    v_mov_b32 v27, v21
    s_swappc_b64 s[60:61], s[32:33]
    s_mov_b64 exec, s[88:89]
    ds_write_b32 v7, v12 offset:8192
    ds_write_b32 v7, v13 offset:8224
    ds_write_b32 v7, v14 offset:8256
    ds_write_b32 v7, v15 offset:8288
    s_mov_b64 exec, -1
    v_mov_b32 v26, v22
    v_mov_b32 v27, v23
    s_swappc_b64 s[60:61], s[32:33]
    s_mov_b64 exec, s[88:89]
    ds_write_b32 v7, v12 offset:8448
    ds_write_b32 v7, v13 offset:8480
    ds_write_b32 v7, v14 offset:8512
    ds_write_b32 v7, v15 offset:8544
    s_mov_b64 exec, -1
    s_mov_b32 s48, s78
    s_mov_b32 s49, s79
    s_mov_b32 s50, 1835008
    s_mov_b32 s51, 0x20000
    s_mov_b32 s52, s28
    s_swappc_b64 s[60:61], s[62:63]
    v_mov_b32 v26, v20
    v_mov_b32 v27, v21
    s_swappc_b64 s[60:61], s[32:33]
    s_mov_b64 exec, s[88:89]
    ds_write_b32 v7, v12 offset:8704
    ds_write_b32 v7, v13 offset:8736
    ds_write_b32 v7, v14 offset:8768
    ds_write_b32 v7, v15 offset:8800
    s_mov_b64 exec, -1
    v_mov_b32 v26, v22
    v_mov_b32 v27, v23
    s_swappc_b64 s[60:61], s[32:33]
    s_mov_b64 exec, s[88:89]
    ds_write_b32 v7, v12 offset:8960
    ds_write_b32 v7, v13 offset:8992
    ds_write_b32 v7, v14 offset:9024
    ds_write_b32 v7, v15 offset:9056
    s_mov_b64 exec, -1
    s_mov_b32 s48, s80
    s_mov_b32 s49, s81
    s_mov_b32 s50, 1835008
    s_mov_b32 s51, 0x20000
    v_lshlrev_b32 v2, 15, v5
    v_lshl_add_u32 v2, v6, 4, v2
    v_cmp_gt_u32 vcc, 32, v3
    v_mov_b32 v25, 0x40000000
    s_nop 0
    v_cndmask_b32 v2, v25, v2, vcc
    s_lshl_b32 s52, s97, 16
    s_lshl_b32 s53, s3, 8
    s_add_u32 s52, s52, s53
    s_movk_i32 s53, 0x400
    v_mov_b32 v25, 0
    v_mov_b32 v40, 1
    s_waitcnt lgkmcnt(0)
    s_mov_b64 exec, 1
    ds_add_u32 v25, v40 offset:6184
    s_mov_b64 exec, -1
    s_swappc_b64 s[60:61], s[62:63]
    s_mov_b32 s31, 0x40000
L_fsync:
    ds_read_b32 v40, v25 offset:6184
    s_waitcnt lgkmcnt(0)
    v_readfirstlane_b32 s30, v40
    s_nop 0
    s_cmp_ge_u32 s30, 4
    s_cbranch_scc1 L_fsync_done
    s_sleep 2
    s_sub_u32 s31, s31, 1
    s_cmp_lg_u32 s31, 0
    s_cbranch_scc1 L_fsync
L_fsync_done:
    v_and_b32 v7, 31, v3
    v_lshlrev_b32 v7, 3, v7
    ds_read_b64 v[64:65], v7 offset:8192
    ds_read_b64 v[66:67], v7 offset:8448
    ds_read_b64 v[68:69], v7 offset:8704
    ds_read_b64 v[70:71], v7 offset:8960
    ds_read_b64 v[72:73], v7 offset:9216
    ds_read_b64 v[74:75], v7 offset:9472
    ds_read_b64 v[76:77], v7 offset:9728
    ds_read_b64 v[78:79], v7 offset:9984
    ds_read_b64 v[80:81], v7 offset:10240
    ds_read_b64 v[82:83], v7 offset:10496
    ds_read_b64 v[84:85], v7 offset:10752
    ds_read_b64 v[86:87], v7 offset:11008
    ds_read_b64 v[88:89], v7 offset:11264
    ds_read_b64 v[90:91], v7 offset:11520
    ds_read_b64 v[92:93], v7 offset:11776
    ds_read_b64 v[94:95], v7 offset:12032
    s_waitcnt lgkmcnt(0)
    v_add_f32 v64, v64, v72
    v_add_f32 v80, v80, v88
    v_add_f32 v65, v65, v73
    v_add_f32 v81, v81, v89
    v_add_f32 v66, v66, v74
    v_add_f32 v82, v82, v90
    v_add_f32 v67, v67, v75
    v_add_f32 v83, v83, v91
    v_add_f32 v68, v68, v76
    v_add_f32 v84, v84, v92
    v_add_f32 v69, v69, v77
    v_add_f32 v85, v85, v93
    v_add_f32 v70, v70, v78
    v_add_f32 v86, v86, v94
    v_add_f32 v71, v71, v79
    v_add_f32 v87, v87, v95
    v_add_f32 v64, v64, v80
    v_add_f32 v65, v65, v81
    v_add_f32 v66, v66, v82
    v_add_f32 v67, v67, v83
    v_add_f32 v68, v68, v84
    v_add_f32 v69, v69, v85
    v_add_f32 v70, v70, v86
    v_add_f32 v71, v71, v87
    v_cvt_pk_bf16_f32 v64, v64, v64
    v_cvt_pk_bf16_f32 v65, v65, v65
    v_cvt_pk_bf16_f32 v66, v66, v66
    v_cvt_pk_bf16_f32 v67, v67, v67
    v_cvt_pk_bf16_f32 v68, v68, v68
    v_cvt_pk_bf16_f32 v69, v69, v69
    v_cvt_pk_bf16_f32 v70, v70, v70
    v_cvt_pk_bf16_f32 v71, v71, v71
    v_and_b32 v64, s14, v64
    v_and_b32 v65, s14, v65
    v_and_b32 v66, s14, v66
    v_and_b32 v67, s14, v67
    v_and_b32 v68, s14, v68
    v_and_b32 v69, s14, v69
    v_and_b32 v70, s14, v70
    v_and_b32 v71, s14, v71
    v_mul_f32 v72, s16, v64
    v_mul_f32 v73, s16, v65
    v_mul_f32 v74, s16, v66
    v_mul_f32 v75, s16, v67
    v_exp_f32 v72, -v72
    v_exp_f32 v73, -v73
    v_exp_f32 v74, -v74
    v_exp_f32 v75, -v75
    v_add_f32 v72, 1.0, v72
    v_add_f32 v73, 1.0, v73
    v_add_f32 v74, 1.0, v74
    v_add_f32 v75, 1.0, v75
    v_rcp_f32 v72, v72
    v_rcp_f32 v73, v73
    v_rcp_f32 v74, v74
    v_rcp_f32 v75, v75
    v_mul_f32 v64, v64, v72
    v_mul_f32 v65, v65, v73
    v_mul_f32 v66, v66, v74
    v_mul_f32 v67, v67, v75
    v_cvt_pk_bf16_f32 v64, v64, v64
    v_cvt_pk_bf16_f32 v65, v65, v65
    v_cvt_pk_bf16_f32 v66, v66, v66
    v_cvt_pk_bf16_f32 v67, v67, v67
    v_and_b32 v64, s14, v64
    v_and_b32 v65, s14, v65
    v_and_b32 v66, s14, v66
    v_and_b32 v67, s14, v67
    v_mul_f32 v64, v64, v68
    v_mul_f32 v65, v65, v69
    v_mul_f32 v66, v66, v70
    v_mul_f32 v67, v67, v71
    v_cvt_pk_bf16_f32 v26, v64, v64
    v_cvt_pk_bf16_f32 v27, v65, v65
    s_swappc_b64 s[60:61], s[32:33]
    v_mov_b32 v40, v12
    v_mov_b32 v41, v13
    v_mov_b32 v42, v14
    v_mov_b32 v43, v15
    v_cvt_pk_bf16_f32 v26, v66, v66
    v_cvt_pk_bf16_f32 v27, v67, v67
    s_swappc_b64 s[60:61], s[32:33]
    v_mov_b32 v64, s47
    v_cndmask_b32 v64, v64, v124, s[90:91]
    v_add_u32 v65, 0x5b, v64
    v_add_u32 v66, 0xc2, v64
    v_add_u32 v67, 0x37, v64
    v_cndmask_b32 v40, v12, v40, s[90:91]
    v_cndmask_b32 v41, v13, v41, s[90:91]
    v_cndmask_b32 v42, v14, v42, s[90:91]
    v_cndmask_b32 v43, v15, v43, s[90:91]
    v_bfi_b32 v40, v16, v64, v40
    v_bfi_b32 v41, v16, v65, v41
    v_bfi_b32 v42, v16, v66, v42
    v_bfi_b32 v43, v16, v67, v43
    v_lshrrev_b32 v44, 3, v6
    v_xor_b32 v44, s57, v44
    v_lshl_add_u32 v44, v44, 4, v5
    v_lshlrev_b32 v44, 12, v44
    v_and_b32 v45, 7, v6
    v_lshl_add_u32 v44, v45, 4, v44
    s_lshl_b32 s28, s3, 14
    s_lshl_b32 s29, s97, 7
    s_add_u32 s28, s28, s29
    s_add_u32 s28, s28, 1572864
    buffer_store_dwordx4 v[40:43], v44, s[20:23], s28 offen sc1
L_noffn:
    s_mov_b32 s48, s72
    s_mov_b32 s49, s73
    s_mov_b32 s50, 4194304
    s_mov_b32 s51, 0x20000
    s_lshl_b32 s52, s58, 17
    s_lshl_b32 s53, s3, 8
    s_add_u32 s52, s52, s53
    v_lshlrev_b32 v2, 15, v5
    v_lshl_add_u32 v2, v6, 4, v2
    s_cmp_lt_u32 s97, 28
    s_cselect_b32 s36, 32, 32
    s_cmp_eq_u32 s56, 0
    s_cselect_b32 s36, 32, s36
    s_mov_b32 s31, 0x40000
L_wpa:
    s_sleep 6
    ds_read_b32 v38, v39 offset:6192
    s_sub_u32 s31, s31, 1
    s_cmp_eq_u32 s31, 0
    s_cbranch_scc1 L_wpa_done
    s_waitcnt lgkmcnt(0)
    v_readfirstlane_b32 s37, v38
    s_nop 0
    s_cmp_gt_u32 s37, s36
    s_cbranch_scc1 L_wpa
L_wpa_done:
    buffer_load_dwordx4 v[128:131], v2, s[48:51], s52 offen offset:0 nt
    buffer_load_dwordx4 v[132:135], v2, s[48:51], s52 offen offset:1024 nt
    buffer_load_dwordx4 v[136:139], v2, s[48:51], s52 offen offset:2048 nt
    buffer_load_dwordx4 v[140:143], v2, s[48:51], s52 offen offset:3072 nt
    s_add_u32 s52, s52, 4096
    s_waitcnt vmcnt(3)
    buffer_load_dwordx4 v[144:147], v2, s[48:51], s52 offen offset:0 nt
    s_waitcnt vmcnt(3)
    buffer_load_dwordx4 v[148:151], v2, s[48:51], s52 offen offset:1024 nt
    s_waitcnt vmcnt(3)
    buffer_load_dwordx4 v[152:155], v2, s[48:51], s52 offen offset:2048 nt
    s_waitcnt vmcnt(3)
    buffer_load_dwordx4 v[156:159], v2, s[48:51], s52 offen offset:3072 nt
    s_add_u32 s52, s52, 4096
    s_waitcnt vmcnt(3)
    buffer_load_dwordx4 v[160:163], v2, s[48:51], s52 offen offset:0 nt
    s_waitcnt vmcnt(3)
    buffer_load_dwordx4 v[164:167], v2, s[48:51], s52 offen offset:1024 nt
    s_waitcnt vmcnt(3)
    buffer_load_dwordx4 v[168:171], v2, s[48:51], s52 offen offset:2048 nt
    s_waitcnt vmcnt(3)
    buffer_load_dwordx4 v[172:175], v2, s[48:51], s52 offen offset:3072 nt
    s_add_u32 s52, s52, 4096
    s_waitcnt vmcnt(3)
    buffer_load_dwordx4 v[176:179], v2, s[48:51], s52 offen offset:0 nt
    s_waitcnt vmcnt(3)
    buffer_load_dwordx4 v[180:183], v2, s[48:51], s52 offen offset:1024 nt
    s_waitcnt vmcnt(3)
    buffer_load_dwordx4 v[184:187], v2, s[48:51], s52 offen offset:2048 nt
    s_waitcnt vmcnt(3)
    buffer_load_dwordx4 v[188:191], v2, s[48:51], s52 offen offset:3072 nt
    s_add_u32 s52, s52, 4096
    s_waitcnt vmcnt(3)
    buffer_load_dwordx4 v[192:195], v2, s[48:51], s52 offen offset:0 nt
    s_waitcnt vmcnt(3)
    buffer_load_dwordx4 v[196:199], v2, s[48:51], s52 offen offset:1024 nt
    s_waitcnt vmcnt(3)
    buffer_load_dwordx4 v[200:203], v2, s[48:51], s52 offen offset:2048 nt
    s_waitcnt vmcnt(3)
    buffer_load_dwordx4 v[204:207], v2, s[48:51], s52 offen offset:3072 nt
    s_add_u32 s52, s52, 4096
    s_waitcnt vmcnt(3)
    buffer_load_dwordx4 v[208:211], v2, s[48:51], s52 offen offset:0 nt
    s_waitcnt vmcnt(3)
    buffer_load_dwordx4 v[212:215], v2, s[48:51], s52 offen offset:1024 nt
    s_waitcnt vmcnt(3)
    buffer_load_dwordx4 v[216:219], v2, s[48:51], s52 offen offset:2048 nt
    s_waitcnt vmcnt(3)
    buffer_load_dwordx4 v[220:223], v2, s[48:51], s52 offen offset:3072 nt
    s_add_u32 s52, s52, 4096
    s_waitcnt vmcnt(3)
    buffer_load_dwordx4 v[224:227], v2, s[48:51], s52 offen offset:0 nt
    s_waitcnt vmcnt(3)
    buffer_load_dwordx4 v[228:231], v2, s[48:51], s52 offen offset:1024 nt
    s_waitcnt vmcnt(3)
    buffer_load_dwordx4 v[232:235], v2, s[48:51], s52 offen offset:2048 nt
    s_waitcnt vmcnt(3)
    buffer_load_dwordx4 v[236:239], v2, s[48:51], s52 offen offset:3072 nt
    s_add_u32 s52, s52, 4096
    s_waitcnt vmcnt(3)
    buffer_load_dwordx4 v[240:243], v2, s[48:51], s52 offen offset:0 nt
    s_waitcnt vmcnt(3)
    buffer_load_dwordx4 v[244:247], v2, s[48:51], s52 offen offset:1024 nt
    s_waitcnt vmcnt(3)
    buffer_load_dwordx4 v[248:251], v2, s[48:51], s52 offen offset:2048 nt
    s_waitcnt vmcnt(3)
    buffer_load_dwordx4 v[252:255], v2, s[48:51], s52 offen offset:3072 nt
    s_add_u32 s52, s52, 4096
    v_lshlrev_b32 v46, 14, v5
    v_lshl_add_u32 v46, v6, 4, v46
    s_lshl_b32 s92, s57, 18
    s_lshl_b32 s93, s3, 16
    s_add_u32 s92, s92, s93
    s_lshl_b32 s93, s58, 2
    s_add_u32 s93, s93, s56
    s_lshl_b32 s96, s93, 7
    s_add_u32 s96, s96, s92
    s_add_u32 s96, s96, 1048576
    s_lshl_b32 s93, s93, 4
    s_lshl_b32 s34, s57, 11
    s_add_u32 s34, s34, 1703936
    s_add_u32 s35, s34, s93
    v_and_b32 v34, 3, v6
    v_lshlrev_b32 v34, 5, v34
    v_lshl_add_u32 v34, v5, 8, v34
    v_lshrrev_b32 v35, 2, v6
    v_lshl_add_u32 v64, v35, 2, v34
    v_add_u32 v64, 2048, v64
    v_add_u32 v65, 1024, v64
    v_add_u32 v66, 2048, v64
    v_add_u32 v67, 3072, v64
    v_mov_b32 v47, 0
    s_lshr_b32 s36, s58, 4
    s_lshl_b32 s36, s36, 3
    s_or_b32 s36, s36, s54
    s_lshl_b32 s37, s57, 4
    s_add_u32 s36, s36, s37
    s_lshl_b32 s38, s36, 14
    s_add_u32 s38, s38, 1048576
    s_lshl_b32 s39, s36, 12
    s_add_u32 s39, s39, 1572864
    s_lshl_b32 s36, s36, 6
    v_lshrrev_b32 v68, 3, v3
    v_and_b32 v69, 7, v3
    v_lshlrev_b32 v70, 9, v68
    v_lshl_add_u32 v70, v69, 4, v70
    v_lshlrev_b32 v71, 6, v68
    v_and_b32 v73, 3, v3
    v_lshl_add_u32 v71, v73, 4, v71
    v_and_b32 v73, 31, v3
    v_lshlrev_b32 v72, 2, v73
    v_add_u32 v72, 7168, v72
    v_lshlrev_b32 v73, 1, v73
    s_lshl_b32 s37, s3, 12
    s_add_u32 s38, s38, s37
    s_lshl_b32 s37, s3, 9
    s_add_u32 s34, s34, s37
    s_lshl_b32 s37, s3, 8
    v_add_u32 v68, s37, v4
    s_and_b32 s29, s58, 8
    s_add_u32 s29, s29, s56
    s_mov_b32 s40, s82
    s_mov_b32 s41, s83
    s_mov_b32 s42, 2048
    s_mov_b32 s43, 0x20000
    s_mov_b32 s31, 0x40000
L_wsw:
    ds_read_b128 v[48:51], v47 offset:6192
    s_sub_u32 s31, s31, 1
    s_cmp_eq_u32 s31, 0
    s_cbranch_scc1 L_wsw_done
    s_waitcnt lgkmcnt(0)
    v_max3_u32 v48, v48, v49, v50
    v_max_u32 v48, v48, v51
    s_nop 0
    v_readfirstlane_b32 s37, v48
    s_nop 0
    s_cmp_le_u32 s37, 27
    s_cbranch_scc1 L_wsw_done
    s_sleep 6
    s_branch L_wsw
L_wsw_done:
    ds_read_b128 v[76:79], v47 offset:6144
    s_waitcnt lgkmcnt(0)
    v_max3_f32 v36, v76, v77, v78
    v_max_f32 v36, v36, v79
    v_or_b32 v40, v36, v124
    v_mul_f32 v36, s16, v36
    v_mul_f32 v76, s16, v76
    v_mul_f32 v77, s16, v77
    v_mul_f32 v78, s16, v78
    v_mul_f32 v79, s16, v79
    v_sub_f32 v76, v76, v36
    v_sub_f32 v77, v77, v36
    v_sub_f32 v78, v78, v36
    v_sub_f32 v79, v79, v36
    v_exp_f32 v76, v76
    v_exp_f32 v77, v77
    v_exp_f32 v78, v78
    v_exp_f32 v79, v79
    v_mov_b32 v42, v126
    v_mov_b32 v43, v127
    s_cmp_lg_u32 s29, 1
    s_cbranch_scc1 L_bar2
    s_cmp_lg_u32 s3, 0
    s_cbranch_scc1 L_dryret
    buffer_load_ushort v74, v73, s[24:27], s36 offen
    v_mov_b32 v92, v124
    v_mov_b32 v93, v125
    v_mov_b32 v94, v126
    v_mov_b32 v95, v127
    s_mov_b32 s31, 0x4000
L_pollf:
    buffer_load_dwordx4 v[80:83], v1, s[20:23], s39 offen offset:0 sc1
    buffer_load_dwordx4 v[84:87], v1, s[20:23], s39 offen offset:1024 sc1
    buffer_load_dwordx4 v[88:91], v1, s[20:23], s39 offen offset:2048 sc1
    s_mov_b32 exec_hi, 0
    buffer_load_dwordx4 v[92:95], v1, s[20:23], s39 offen offset:3072 sc1
    s_mov_b64 exec, -1
    s_waitcnt vmcnt(0)
    v_xor_b32 v100, v80, v124
    v_xor_b32 v101, v81, v125
    v_xor_b32 v102, v82, v126
    v_xor_b32 v103, v83, v127
    v_xor_b32 v104, v84, v124
    v_xor_b32 v105, v85, v125
    v_xor_b32 v106, v86, v126
    v_xor_b32 v107, v87, v127
    v_xor_b32 v108, v88, v124
    v_xor_b32 v109, v89, v125
    v_xor_b32 v110, v90, v126
    v_xor_b32 v111, v91, v127
    v_xor_b32 v112, v92, v124
    v_xor_b32 v113, v93, v125
    v_xor_b32 v114, v94, v126
    v_xor_b32 v115, v95, v127
    v_or3_b32 v75, v100, v101, v102
    v_or3_b32 v122, v103, v104, v105
    v_or3_b32 v75, v75, v106, v107
    v_or3_b32 v122, v122, v108, v109
    v_or3_b32 v75, v75, v110, v111
    v_or3_b32 v122, v122, v112, v113
    v_or3_b32 v75, v75, v114, v115
    v_or_b32 v75, v75, v122
    v_and_b32 v75, 0xff, v75
    v_cmp_ne_u32 vcc, 0, v75
    s_cbranch_vccz L_pollf_done
    s_sleep 32
    s_sub_u32 s31, s31, 1
    s_cmp_lg_u32 s31, 0
    s_cbranch_scc1 L_pollf
L_pollf_done:
    v_add_f32 v80, v100, v104
    v_add_f32 v88, v108, v112
    v_add_f32 v81, v101, v105
    v_add_f32 v89, v109, v113
    v_add_f32 v82, v102, v106
    v_add_f32 v90, v110, v114
    v_add_f32 v83, v103, v107
    v_add_f32 v91, v111, v115
    v_add_f32 v80, v80, v88
    v_add_f32 v81, v81, v89
    v_add_f32 v82, v82, v90
    v_add_f32 v83, v83, v91
    v_add_f32_dpp v123, v80, v80 row_ror:8 row_mask:0xf bank_mask:0xf
    v_add_f32_dpp v122, v82, v82 row_ror:8 row_mask:0xf bank_mask:0xf
    s_nop 0
    v_add_f32_dpp v123, v81, v81 row_ror:8 row_mask:0xf bank_mask:0xc
    v_add_f32_dpp v122, v83, v83 row_ror:8 row_mask:0xf bank_mask:0xc
    s_nop 1
    v_permlane16_swap_b32 v123, v122
    v_add_f32 v123, v123, v122
    v_mov_b32 v122, v123
    s_nop 1
    v_permlane32_swap_b32 v123, v122
    v_add_f32 v123, v123, v122
    v_cvt_pk_bf16_f32 v123, v123, v123
    v_and_b32 v123, s14, v123
    v_mul_f32 v122, s16, v123
    v_exp_f32 v122, -v122
    s_nop 0
    v_add_f32 v122, 1.0, v122
    v_rcp_f32 v122, v122
    s_nop 0
    v_mul_f32 v123, v123, v122
    v_cvt_pk_bf16_f32 v123, v123, v123
    v_and_b32 v123, s14, v123
    v_lshlrev_b32 v74, 16, v74
    s_mov_b32 s13, 1
    s_branch L_polla_done
L_dryret:
    s_mov_b32 s13, 0
L_bar2:
    s_cmp_lg_u32 s3, 3
    s_cbranch_scc1 L_noml
    s_mov_b32 s31, 0x80000
L_wl:
    ds_read_b128 v[48:51], v47 offset:6160
    s_sub_u32 s31, s31, 1
    s_waitcnt lgkmcnt(0)
    s_cmp_eq_u32 s31, 0
    s_cbranch_scc1 L_wl_done
    v_max3_u32 v41, v48, v49, v50
    v_max_u32 v41, v41, v51
    s_nop 0
    v_readfirstlane_b32 s37, v41
    s_nop 0
    s_cmp_lg_u32 s37, -1
    s_cbranch_scc1 L_wl_done
    s_sleep 3
    s_branch L_wl
L_wl_done:
    v_mul_f32 v41, v48, v76
    v_fmac_f32 v41, v49, v77
    v_fmac_f32 v41, v50, v78
    v_fmac_f32 v41, v51, v79
    v_bfi_b32 v41, v16, v125, v41
    s_waitcnt vmcnt(0)
    s_mov_b64 exec, 1
    buffer_store_dwordx4 v[40:43], v47, s[20:23], s35 offen sc1
    s_mov_b64 exec, -1
    s_branch L_bar2b
L_noml:
    s_waitcnt vmcnt(0)
L_bar2b:
    s_waitcnt lgkmcnt(0)
    s_barrier
    ds_read2_b32 v[52:53], v64 offset0:0 offset1:4
    ds_read2_b32 v[54:55], v65 offset0:0 offset1:4
    ds_read2_b32 v[56:57], v66 offset0:0 offset1:4
    ds_read2_b32 v[58:59], v67 offset0:0 offset1:4
    s_waitcnt lgkmcnt(2)
    v_mul_f32 v26, v52, v76
    v_mul_f32 v27, v53, v76
    v_fmac_f32 v26, v54, v77
    v_fmac_f32 v27, v55, v77
    s_waitcnt lgkmcnt(0)
    v_fmac_f32 v26, v56, v78
    v_fmac_f32 v27, v57, v78
    v_fmac_f32 v26, v58, v79
    v_fmac_f32 v27, v59, v79
    v_cvt_pk_bf16_f32 v26, v26, v26
    v_cvt_pk_bf16_f32 v27, v27, v27
    s_swappc_b64 s[60:61], s[4:5]
    v_bfi_b32 v12, v16, v124, v12
    v_bfi_b32 v13, v16, v125, v13
    v_bfi_b32 v14, v16, v126, v14
    v_bfi_b32 v15, v16, v127, v15
    s_mov_b64 exec, s[90:91]
    buffer_store_dwordx4 v[12:15], v46, s[20:23], s96 offen sc1
    s_mov_b64 exec, -1
    s_cmp_lg_u32 s29, 1
    s_cbranch_scc1 L_end
    s_mov_b32 s31, 0x8000
    s_mov_b64 s[10:11], -1
    s_waitcnt vmcnt(0)
L_polla:
L_polla1:
    s_mov_b64 exec, s[10:11]
    buffer_load_dwordx4 v[80:83], v70, s[20:23], s38 offen offset:0 sc1
    buffer_load_dwordx4 v[84:87], v70, s[20:23], s38 offen offset:128 sc1
    buffer_load_dwordx4 v[88:91], v70, s[20:23], s38 offen offset:256 sc1
    buffer_load_dwordx4 v[92:95], v70, s[20:23], s38 offen offset:384 sc1
    buffer_load_dwordx4 v[96:99], v71, s[20:23], s34 offen sc1
    s_mov_b64 exec, -1
    s_waitcnt vmcnt(0)
    v_xor_b32 v100, v80, v124
    v_xor_b32 v101, v81, v125
    v_xor_b32 v102, v82, v126
    v_xor_b32 v103, v83, v127
    v_xor_b32 v104, v84, v124
    v_xor_b32 v105, v85, v125
    v_xor_b32 v106, v86, v126
    v_xor_b32 v107, v87, v127
    v_xor_b32 v108, v88, v124
    v_xor_b32 v109, v89, v125
    v_xor_b32 v110, v90, v126
    v_xor_b32 v111, v91, v127
    v_xor_b32 v112, v92, v124
    v_xor_b32 v113, v93, v125
    v_xor_b32 v114, v94, v126
    v_xor_b32 v115, v95, v127
    v_xor_b32 v116, v96, v124
    v_xor_b32 v117, v97, v125
    v_xor_b32 v118, v98, v126
    v_xor_b32 v119, v99, v127
    v_or3_b32 v75, v100, v101, v102
    v_or3_b32 v122, v103, v104, v105
    v_or3_b32 v75, v75, v106, v107
    v_or3_b32 v122, v122, v108, v109
    v_or3_b32 v75, v75, v110, v111
    v_or3_b32 v122, v122, v112, v113
    v_or3_b32 v75, v75, v114, v115
    v_or3_b32 v122, v122, v116, v117
    v_or3_b32 v75, v75, v118, v119
    v_or_b32 v75, v75, v122
    v_and_b32 v75, 0xff, v75
    v_cmp_ne_u32 s[10:11], 0, v75
    s_sub_u32 s31, s31, 1
    s_cmp_eq_u32 s31, 0
    s_cbranch_scc1 L_polla_done
    s_cmp_lg_u64 s[10:11], 0
    s_cbranch_scc1 L_polla
L_polla_done:
    v_mul_f32 v52, s16, v116
    s_nop 1
    v_max_f32_dpp v120, v52, v52 quad_perm:[1,0,3,2] row_mask:0xf bank_mask:0xf
    s_nop 1
    v_max_f32_dpp v120, v120, v120 quad_perm:[2,3,0,1] row_mask:0xf bank_mask:0xf
    v_sub_f32 v52, v52, v120
    v_exp_f32 v52, v52
    s_nop 0
    v_mul_f32 v121, v117, v52
    v_mul_f32_dpp v56, v52, v100 quad_perm:[0,0,0,0] row_mask:0xf bank_mask:0xf
    v_mul_f32_dpp v57, v52, v101 quad_perm:[0,0,0,0] row_mask:0xf bank_mask:0xf
    v_mul_f32_dpp v58, v52, v102 quad_perm:[0,0,0,0] row_mask:0xf bank_mask:0xf
    v_mul_f32_dpp v59, v52, v103 quad_perm:[0,0,0,0] row_mask:0xf bank_mask:0xf
    v_add_f32_dpp v121, v121, v121 quad_perm:[1,0,3,2] row_mask:0xf bank_mask:0xf
    v_fmac_f32_dpp v56, v52, v104 quad_perm:[1,1,1,1] row_mask:0xf bank_mask:0xf
    v_fmac_f32_dpp v57, v52, v105 quad_perm:[1,1,1,1] row_mask:0xf bank_mask:0xf
    v_fmac_f32_dpp v58, v52, v106 quad_perm:[1,1,1,1] row_mask:0xf bank_mask:0xf
    v_fmac_f32_dpp v59, v52, v107 quad_perm:[1,1,1,1] row_mask:0xf bank_mask:0xf
    v_add_f32_dpp v121, v121, v121 quad_perm:[2,3,0,1] row_mask:0xf bank_mask:0xf
    v_fmac_f32_dpp v56, v52, v108 quad_perm:[2,2,2,2] row_mask:0xf bank_mask:0xf
    v_fmac_f32_dpp v57, v52, v109 quad_perm:[2,2,2,2] row_mask:0xf bank_mask:0xf
    v_fmac_f32_dpp v58, v52, v110 quad_perm:[2,2,2,2] row_mask:0xf bank_mask:0xf
    v_fmac_f32_dpp v59, v52, v111 quad_perm:[2,2,2,2] row_mask:0xf bank_mask:0xf
    v_rcp_f32 v121, v121
    v_fmac_f32_dpp v56, v52, v112 quad_perm:[3,3,3,3] row_mask:0xf bank_mask:0xf
    v_fmac_f32_dpp v57, v52, v113 quad_perm:[3,3,3,3] row_mask:0xf bank_mask:0xf
    v_fmac_f32_dpp v58, v52, v114 quad_perm:[3,3,3,3] row_mask:0xf bank_mask:0xf
    v_fmac_f32_dpp v59, v52, v115 quad_perm:[3,3,3,3] row_mask:0xf bank_mask:0xf
    v_mul_f32 v56, v56, v121
    v_mul_f32 v57, v57, v121
    v_mul_f32 v58, v58, v121
    v_mul_f32 v59, v59, v121
    v_add_f32_dpp v122, v56, v56 row_ror:8 row_mask:0xf bank_mask:0xf
    v_add_f32_dpp v52, v58, v58 row_ror:8 row_mask:0xf bank_mask:0xf
    s_nop 0
    v_add_f32_dpp v122, v57, v57 row_ror:8 row_mask:0xf bank_mask:0xc
    v_add_f32_dpp v52, v59, v59 row_ror:8 row_mask:0xf bank_mask:0xc
    s_nop 1
    v_permlane16_swap_b32 v122, v52
    v_add_f32 v122, v122, v52
    ds_write_b32 v68, v122 offset:7168
    s_waitcnt lgkmcnt(0)
    s_cmp_eq_u32 s13, 1
    s_cbranch_scc1 L_nobar3
    s_barrier
    s_cmp_lg_u32 s3, 0
    s_cbranch_scc1 L_end
L_nobar3:
    ds_read2_b32 v[52:53], v72 offset0:0 offset1:32
    ds_read2_b32 v[54:55], v72 offset0:64 offset1:96
    ds_read2_b32 v[56:57], v72 offset0:128 offset1:160
    ds_read2_b32 v[58:59], v72 offset0:192 offset1:224
    s_waitcnt lgkmcnt(0)
    v_add_f32 v52, v52, v53
    v_add_f32 v54, v54, v55
    v_add_f32 v56, v56, v57
    v_add_f32 v58, v58, v59
    v_add_f32 v52, v52, v54
    v_add_f32 v56, v56, v58
    v_add_f32 v122, v52, v56
    v_cvt_pk_bf16_f32 v122, v122, v122
    v_and_b32 v122, s14, v122
    v_mul_f32 v122, v122, v123
    v_cvt_pk_bf16_f32 v122, v122, v122
    v_and_b32 v122, s14, v122
    v_add_f32 v122, v122, v74
    v_cvt_pk_bf16_f32 v122, v122, v122
    s_cmp_eq_u32 s13, 1
    s_cbranch_scc1 L_dryret
    s_mov_b32 exec_hi, 0
    buffer_store_short v122, v73, s[40:43], s36 offen
    s_cmp_lg_u32 s58, 0
    s_cbranch_scc1 L_noep
    s_lshl_b32 s30, s57, 8
    s_add_u32 s30, s30, 1712128
    s_mov_b64 exec, 1
    buffer_store_dword v124, v47, s[20:23], s30 offen sc1
L_noep:
L_end:
    s_endpgm
L_load32:
    buffer_load_dwordx4 v[128:131], v2, s[48:51], s52 offen nt
    s_add_u32 s52, s52, s53
    buffer_load_dwordx4 v[132:135], v2, s[48:51], s52 offen nt
    s_add_u32 s52, s52, s53
    buffer_load_dwordx4 v[136:139], v2, s[48:51], s52 offen nt
    s_add_u32 s52, s52, s53
    buffer_load_dwordx4 v[140:143], v2, s[48:51], s52 offen nt
    s_add_u32 s52, s52, s53
    buffer_load_dwordx4 v[144:147], v2, s[48:51], s52 offen nt
    s_add_u32 s52, s52, s53
    buffer_load_dwordx4 v[148:151], v2, s[48:51], s52 offen nt
    s_add_u32 s52, s52, s53
    buffer_load_dwordx4 v[152:155], v2, s[48:51], s52 offen nt
    s_add_u32 s52, s52, s53
    buffer_load_dwordx4 v[156:159], v2, s[48:51], s52 offen nt
    s_add_u32 s52, s52, s53
    s_waitcnt vmcnt(7)
    buffer_load_dwordx4 v[160:163], v2, s[48:51], s52 offen nt
    s_add_u32 s52, s52, s53
    s_waitcnt vmcnt(7)
    buffer_load_dwordx4 v[164:167], v2, s[48:51], s52 offen nt
    s_add_u32 s52, s52, s53
    s_waitcnt vmcnt(7)
    buffer_load_dwordx4 v[168:171], v2, s[48:51], s52 offen nt
    s_add_u32 s52, s52, s53
    s_waitcnt vmcnt(7)
    buffer_load_dwordx4 v[172:175], v2, s[48:51], s52 offen nt
    s_add_u32 s52, s52, s53
    s_waitcnt vmcnt(7)
    buffer_load_dwordx4 v[176:179], v2, s[48:51], s52 offen nt
    s_add_u32 s52, s52, s53
    s_waitcnt vmcnt(7)
    buffer_load_dwordx4 v[180:183], v2, s[48:51], s52 offen nt
    s_add_u32 s52, s52, s53
    s_waitcnt vmcnt(7)
    buffer_load_dwordx4 v[184:187], v2, s[48:51], s52 offen nt
    s_add_u32 s52, s52, s53
    s_waitcnt vmcnt(7)
    buffer_load_dwordx4 v[188:191], v2, s[48:51], s52 offen nt
    s_add_u32 s52, s52, s53
    s_waitcnt vmcnt(7)
    buffer_load_dwordx4 v[192:195], v2, s[48:51], s52 offen nt
    s_add_u32 s52, s52, s53
    s_waitcnt vmcnt(7)
    buffer_load_dwordx4 v[196:199], v2, s[48:51], s52 offen nt
    s_add_u32 s52, s52, s53
    s_waitcnt vmcnt(7)
    buffer_load_dwordx4 v[200:203], v2, s[48:51], s52 offen nt
    s_add_u32 s52, s52, s53
    s_waitcnt vmcnt(7)
    buffer_load_dwordx4 v[204:207], v2, s[48:51], s52 offen nt
    s_add_u32 s52, s52, s53
    s_waitcnt vmcnt(7)
    buffer_load_dwordx4 v[208:211], v2, s[48:51], s52 offen nt
    s_add_u32 s52, s52, s53
    s_waitcnt vmcnt(7)
    buffer_load_dwordx4 v[212:215], v2, s[48:51], s52 offen nt
    s_add_u32 s52, s52, s53
    s_waitcnt vmcnt(7)
    buffer_load_dwordx4 v[216:219], v2, s[48:51], s52 offen nt
    s_add_u32 s52, s52, s53
    s_waitcnt vmcnt(7)
    buffer_load_dwordx4 v[220:223], v2, s[48:51], s52 offen nt
    s_add_u32 s52, s52, s53
    s_waitcnt vmcnt(7)
    buffer_load_dwordx4 v[224:227], v2, s[48:51], s52 offen nt
    s_add_u32 s52, s52, s53
    s_waitcnt vmcnt(7)
    buffer_load_dwordx4 v[228:231], v2, s[48:51], s52 offen nt
    s_add_u32 s52, s52, s53
    s_waitcnt vmcnt(7)
    buffer_load_dwordx4 v[232:235], v2, s[48:51], s52 offen nt
    s_add_u32 s52, s52, s53
    s_waitcnt vmcnt(7)
    buffer_load_dwordx4 v[236:239], v2, s[48:51], s52 offen nt
    s_add_u32 s52, s52, s53
    s_waitcnt vmcnt(7)
    buffer_load_dwordx4 v[240:243], v2, s[48:51], s52 offen nt
    s_add_u32 s52, s52, s53
    s_waitcnt vmcnt(7)
    buffer_load_dwordx4 v[244:247], v2, s[48:51], s52 offen nt
    s_add_u32 s52, s52, s53
    s_waitcnt vmcnt(7)
    buffer_load_dwordx4 v[248:251], v2, s[48:51], s52 offen nt
    s_add_u32 s52, s52, s53
    s_waitcnt vmcnt(7)
    buffer_load_dwordx4 v[252:255], v2, s[48:51], s52 offen nt
    s_setpc_b64 s[60:61]
L_gemv:
    s_waitcnt vmcnt(0)
L_gemv2:
    s_nop 1
    v_and_b32_dpp v28, v26, v8 row_newbcast:0 row_mask:0xf bank_mask:0xf
    v_and_b32_dpp v29, v26, v9 row_newbcast:0 row_mask:0xf bank_mask:0xf
    v_and_b32_dpp v30, v26, v10 row_newbcast:0 row_mask:0xf bank_mask:0xf
    v_and_b32_dpp v31, v26, v11 row_newbcast:0 row_mask:0xf bank_mask:0xf
    v_and_b32_dpp v32, v27, v8 row_newbcast:0 row_mask:0xf bank_mask:0xf
    v_and_b32_dpp v33, v27, v9 row_newbcast:0 row_mask:0xf bank_mask:0xf
    v_and_b32_dpp v34, v27, v10 row_newbcast:0 row_mask:0xf bank_mask:0xf
    v_and_b32_dpp v35, v27, v11 row_newbcast:0 row_mask:0xf bank_mask:0xf
    v_mfma_f32_16x16x32_bf16 v[12:15], v[128:131], v[28:31], 0
    v_and_b32_dpp v28, v26, v8 row_newbcast:1 row_mask:0xf bank_mask:0xf
    v_and_b32_dpp v29, v26, v9 row_newbcast:1 row_mask:0xf bank_mask:0xf
    v_and_b32_dpp v30, v26, v10 row_newbcast:1 row_mask:0xf bank_mask:0xf
    v_and_b32_dpp v31, v26, v11 row_newbcast:1 row_mask:0xf bank_mask:0xf
    v_mfma_f32_16x16x32_bf16 v[12:15], v[132:135], v[32:35], v[12:15]
    v_and_b32_dpp v32, v27, v8 row_newbcast:1 row_mask:0xf bank_mask:0xf
    v_and_b32_dpp v33, v27, v9 row_newbcast:1 row_mask:0xf bank_mask:0xf
    v_and_b32_dpp v34, v27, v10 row_newbcast:1 row_mask:0xf bank_mask:0xf
    v_and_b32_dpp v35, v27, v11 row_newbcast:1 row_mask:0xf bank_mask:0xf
    v_mfma_f32_16x16x32_bf16 v[12:15], v[136:139], v[28:31], v[12:15]
    v_and_b32_dpp v28, v26, v8 row_newbcast:2 row_mask:0xf bank_mask:0xf
    v_and_b32_dpp v29, v26, v9 row_newbcast:2 row_mask:0xf bank_mask:0xf
    v_and_b32_dpp v30, v26, v10 row_newbcast:2 row_mask:0xf bank_mask:0xf
    v_and_b32_dpp v31, v26, v11 row_newbcast:2 row_mask:0xf bank_mask:0xf
    v_mfma_f32_16x16x32_bf16 v[12:15], v[140:143], v[32:35], v[12:15]
    v_and_b32_dpp v32, v27, v8 row_newbcast:2 row_mask:0xf bank_mask:0xf
    v_and_b32_dpp v33, v27, v9 row_newbcast:2 row_mask:0xf bank_mask:0xf
    v_and_b32_dpp v34, v27, v10 row_newbcast:2 row_mask:0xf bank_mask:0xf
    v_and_b32_dpp v35, v27, v11 row_newbcast:2 row_mask:0xf bank_mask:0xf
    v_mfma_f32_16x16x32_bf16 v[12:15], v[144:147], v[28:31], v[12:15]
    v_and_b32_dpp v28, v26, v8 row_newbcast:3 row_mask:0xf bank_mask:0xf
    v_and_b32_dpp v29, v26, v9 row_newbcast:3 row_mask:0xf bank_mask:0xf
    v_and_b32_dpp v30, v26, v10 row_newbcast:3 row_mask:0xf bank_mask:0xf
    v_and_b32_dpp v31, v26, v11 row_newbcast:3 row_mask:0xf bank_mask:0xf
    v_mfma_f32_16x16x32_bf16 v[12:15], v[148:151], v[32:35], v[12:15]
    v_and_b32_dpp v32, v27, v8 row_newbcast:3 row_mask:0xf bank_mask:0xf
    v_and_b32_dpp v33, v27, v9 row_newbcast:3 row_mask:0xf bank_mask:0xf
    v_and_b32_dpp v34, v27, v10 row_newbcast:3 row_mask:0xf bank_mask:0xf
    v_and_b32_dpp v35, v27, v11 row_newbcast:3 row_mask:0xf bank_mask:0xf
    v_mfma_f32_16x16x32_bf16 v[12:15], v[152:155], v[28:31], v[12:15]
    v_and_b32_dpp v28, v26, v8 row_newbcast:4 row_mask:0xf bank_mask:0xf
    v_and_b32_dpp v29, v26, v9 row_newbcast:4 row_mask:0xf bank_mask:0xf
    v_and_b32_dpp v30, v26, v10 row_newbcast:4 row_mask:0xf bank_mask:0xf
    v_and_b32_dpp v31, v26, v11 row_newbcast:4 row_mask:0xf bank_mask:0xf
    v_mfma_f32_16x16x32_bf16 v[12:15], v[156:159], v[32:35], v[12:15]
    v_and_b32_dpp v32, v27, v8 row_newbcast:4 row_mask:0xf bank_mask:0xf
    v_and_b32_dpp v33, v27, v9 row_newbcast:4 row_mask:0xf bank_mask:0xf
    v_and_b32_dpp v34, v27, v10 row_newbcast:4 row_mask:0xf bank_mask:0xf
    v_and_b32_dpp v35, v27, v11 row_newbcast:4 row_mask:0xf bank_mask:0xf
    v_mfma_f32_16x16x32_bf16 v[12:15], v[160:163], v[28:31], v[12:15]
    v_and_b32_dpp v28, v26, v8 row_newbcast:5 row_mask:0xf bank_mask:0xf
    v_and_b32_dpp v29, v26, v9 row_newbcast:5 row_mask:0xf bank_mask:0xf
    v_and_b32_dpp v30, v26, v10 row_newbcast:5 row_mask:0xf bank_mask:0xf
    v_and_b32_dpp v31, v26, v11 row_newbcast:5 row_mask:0xf bank_mask:0xf
    v_mfma_f32_16x16x32_bf16 v[12:15], v[164:167], v[32:35], v[12:15]
    v_and_b32_dpp v32, v27, v8 row_newbcast:5 row_mask:0xf bank_mask:0xf
    v_and_b32_dpp v33, v27, v9 row_newbcast:5 row_mask:0xf bank_mask:0xf
    v_and_b32_dpp v34, v27, v10 row_newbcast:5 row_mask:0xf bank_mask:0xf
    v_and_b32_dpp v35, v27, v11 row_newbcast:5 row_mask:0xf bank_mask:0xf
    v_mfma_f32_16x16x32_bf16 v[12:15], v[168:171], v[28:31], v[12:15]
    v_and_b32_dpp v28, v26, v8 row_newbcast:6 row_mask:0xf bank_mask:0xf
    v_and_b32_dpp v29, v26, v9 row_newbcast:6 row_mask:0xf bank_mask:0xf
    v_and_b32_dpp v30, v26, v10 row_newbcast:6 row_mask:0xf bank_mask:0xf
    v_and_b32_dpp v31, v26, v11 row_newbcast:6 row_mask:0xf bank_mask:0xf
    v_mfma_f32_16x16x32_bf16 v[12:15], v[172:175], v[32:35], v[12:15]
    v_and_b32_dpp v32, v27, v8 row_newbcast:6 row_mask:0xf bank_mask:0xf
    v_and_b32_dpp v33, v27, v9 row_newbcast:6 row_mask:0xf bank_mask:0xf
    v_and_b32_dpp v34, v27, v10 row_newbcast:6 row_mask:0xf bank_mask:0xf
    v_and_b32_dpp v35, v27, v11 row_newbcast:6 row_mask:0xf bank_mask:0xf
    v_mfma_f32_16x16x32_bf16 v[12:15], v[176:179], v[28:31], v[12:15]
    v_and_b32_dpp v28, v26, v8 row_newbcast:7 row_mask:0xf bank_mask:0xf
    v_and_b32_dpp v29, v26, v9 row_newbcast:7 row_mask:0xf bank_mask:0xf
    v_and_b32_dpp v30, v26, v10 row_newbcast:7 row_mask:0xf bank_mask:0xf
    v_and_b32_dpp v31, v26, v11 row_newbcast:7 row_mask:0xf bank_mask:0xf
    v_mfma_f32_16x16x32_bf16 v[12:15], v[180:183], v[32:35], v[12:15]
    v_and_b32_dpp v32, v27, v8 row_newbcast:7 row_mask:0xf bank_mask:0xf
    v_and_b32_dpp v33, v27, v9 row_newbcast:7 row_mask:0xf bank_mask:0xf
    v_and_b32_dpp v34, v27, v10 row_newbcast:7 row_mask:0xf bank_mask:0xf
    v_and_b32_dpp v35, v27, v11 row_newbcast:7 row_mask:0xf bank_mask:0xf
    v_mfma_f32_16x16x32_bf16 v[12:15], v[184:187], v[28:31], v[12:15]
    v_and_b32_dpp v28, v26, v8 row_newbcast:8 row_mask:0xf bank_mask:0xf
    v_and_b32_dpp v29, v26, v9 row_newbcast:8 row_mask:0xf bank_mask:0xf
    v_and_b32_dpp v30, v26, v10 row_newbcast:8 row_mask:0xf bank_mask:0xf
    v_and_b32_dpp v31, v26, v11 row_newbcast:8 row_mask:0xf bank_mask:0xf
    v_mfma_f32_16x16x32_bf16 v[12:15], v[188:191], v[32:35], v[12:15]
    v_and_b32_dpp v32, v27, v8 row_newbcast:8 row_mask:0xf bank_mask:0xf
    v_and_b32_dpp v33, v27, v9 row_newbcast:8 row_mask:0xf bank_mask:0xf
    v_and_b32_dpp v34, v27, v10 row_newbcast:8 row_mask:0xf bank_mask:0xf
    v_and_b32_dpp v35, v27, v11 row_newbcast:8 row_mask:0xf bank_mask:0xf
    v_mfma_f32_16x16x32_bf16 v[12:15], v[192:195], v[28:31], v[12:15]
    v_and_b32_dpp v28, v26, v8 row_newbcast:9 row_mask:0xf bank_mask:0xf
    v_and_b32_dpp v29, v26, v9 row_newbcast:9 row_mask:0xf bank_mask:0xf
    v_and_b32_dpp v30, v26, v10 row_newbcast:9 row_mask:0xf bank_mask:0xf
    v_and_b32_dpp v31, v26, v11 row_newbcast:9 row_mask:0xf bank_mask:0xf
    v_mfma_f32_16x16x32_bf16 v[12:15], v[196:199], v[32:35], v[12:15]
    v_and_b32_dpp v32, v27, v8 row_newbcast:9 row_mask:0xf bank_mask:0xf
    v_and_b32_dpp v33, v27, v9 row_newbcast:9 row_mask:0xf bank_mask:0xf
    v_and_b32_dpp v34, v27, v10 row_newbcast:9 row_mask:0xf bank_mask:0xf
    v_and_b32_dpp v35, v27, v11 row_newbcast:9 row_mask:0xf bank_mask:0xf
    v_mfma_f32_16x16x32_bf16 v[12:15], v[200:203], v[28:31], v[12:15]
    v_and_b32_dpp v28, v26, v8 row_newbcast:10 row_mask:0xf bank_mask:0xf
    v_and_b32_dpp v29, v26, v9 row_newbcast:10 row_mask:0xf bank_mask:0xf
    v_and_b32_dpp v30, v26, v10 row_newbcast:10 row_mask:0xf bank_mask:0xf
    v_and_b32_dpp v31, v26, v11 row_newbcast:10 row_mask:0xf bank_mask:0xf
    v_mfma_f32_16x16x32_bf16 v[12:15], v[204:207], v[32:35], v[12:15]
    v_and_b32_dpp v32, v27, v8 row_newbcast:10 row_mask:0xf bank_mask:0xf
    v_and_b32_dpp v33, v27, v9 row_newbcast:10 row_mask:0xf bank_mask:0xf
    v_and_b32_dpp v34, v27, v10 row_newbcast:10 row_mask:0xf bank_mask:0xf
    v_and_b32_dpp v35, v27, v11 row_newbcast:10 row_mask:0xf bank_mask:0xf
    v_mfma_f32_16x16x32_bf16 v[12:15], v[208:211], v[28:31], v[12:15]
    v_and_b32_dpp v28, v26, v8 row_newbcast:11 row_mask:0xf bank_mask:0xf
    v_and_b32_dpp v29, v26, v9 row_newbcast:11 row_mask:0xf bank_mask:0xf
    v_and_b32_dpp v30, v26, v10 row_newbcast:11 row_mask:0xf bank_mask:0xf
    v_and_b32_dpp v31, v26, v11 row_newbcast:11 row_mask:0xf bank_mask:0xf
    v_mfma_f32_16x16x32_bf16 v[12:15], v[212:215], v[32:35], v[12:15]
    v_and_b32_dpp v32, v27, v8 row_newbcast:11 row_mask:0xf bank_mask:0xf
    v_and_b32_dpp v33, v27, v9 row_newbcast:11 row_mask:0xf bank_mask:0xf
    v_and_b32_dpp v34, v27, v10 row_newbcast:11 row_mask:0xf bank_mask:0xf
    v_and_b32_dpp v35, v27, v11 row_newbcast:11 row_mask:0xf bank_mask:0xf
    v_mfma_f32_16x16x32_bf16 v[12:15], v[216:219], v[28:31], v[12:15]
    v_and_b32_dpp v28, v26, v8 row_newbcast:12 row_mask:0xf bank_mask:0xf
    v_and_b32_dpp v29, v26, v9 row_newbcast:12 row_mask:0xf bank_mask:0xf
    v_and_b32_dpp v30, v26, v10 row_newbcast:12 row_mask:0xf bank_mask:0xf
    v_and_b32_dpp v31, v26, v11 row_newbcast:12 row_mask:0xf bank_mask:0xf
    v_mfma_f32_16x16x32_bf16 v[12:15], v[220:223], v[32:35], v[12:15]
    v_and_b32_dpp v32, v27, v8 row_newbcast:12 row_mask:0xf bank_mask:0xf
    v_and_b32_dpp v33, v27, v9 row_newbcast:12 row_mask:0xf bank_mask:0xf
    v_and_b32_dpp v34, v27, v10 row_newbcast:12 row_mask:0xf bank_mask:0xf
    v_and_b32_dpp v35, v27, v11 row_newbcast:12 row_mask:0xf bank_mask:0xf
    v_mfma_f32_16x16x32_bf16 v[12:15], v[224:227], v[28:31], v[12:15]
    v_and_b32_dpp v28, v26, v8 row_newbcast:13 row_mask:0xf bank_mask:0xf
    v_and_b32_dpp v29, v26, v9 row_newbcast:13 row_mask:0xf bank_mask:0xf
    v_and_b32_dpp v30, v26, v10 row_newbcast:13 row_mask:0xf bank_mask:0xf
    v_and_b32_dpp v31, v26, v11 row_newbcast:13 row_mask:0xf bank_mask:0xf
    v_mfma_f32_16x16x32_bf16 v[12:15], v[228:231], v[32:35], v[12:15]
    v_and_b32_dpp v32, v27, v8 row_newbcast:13 row_mask:0xf bank_mask:0xf
    v_and_b32_dpp v33, v27, v9 row_newbcast:13 row_mask:0xf bank_mask:0xf
    v_and_b32_dpp v34, v27, v10 row_newbcast:13 row_mask:0xf bank_mask:0xf
    v_and_b32_dpp v35, v27, v11 row_newbcast:13 row_mask:0xf bank_mask:0xf
    v_mfma_f32_16x16x32_bf16 v[12:15], v[232:235], v[28:31], v[12:15]
    v_and_b32_dpp v28, v26, v8 row_newbcast:14 row_mask:0xf bank_mask:0xf
    v_and_b32_dpp v29, v26, v9 row_newbcast:14 row_mask:0xf bank_mask:0xf
    v_and_b32_dpp v30, v26, v10 row_newbcast:14 row_mask:0xf bank_mask:0xf
    v_and_b32_dpp v31, v26, v11 row_newbcast:14 row_mask:0xf bank_mask:0xf
    v_mfma_f32_16x16x32_bf16 v[12:15], v[236:239], v[32:35], v[12:15]
    v_and_b32_dpp v32, v27, v8 row_newbcast:14 row_mask:0xf bank_mask:0xf
    v_and_b32_dpp v33, v27, v9 row_newbcast:14 row_mask:0xf bank_mask:0xf
    v_and_b32_dpp v34, v27, v10 row_newbcast:14 row_mask:0xf bank_mask:0xf
    v_and_b32_dpp v35, v27, v11 row_newbcast:14 row_mask:0xf bank_mask:0xf
    v_mfma_f32_16x16x32_bf16 v[12:15], v[240:243], v[28:31], v[12:15]
    v_and_b32_dpp v28, v26, v8 row_newbcast:15 row_mask:0xf bank_mask:0xf
    v_and_b32_dpp v29, v26, v9 row_newbcast:15 row_mask:0xf bank_mask:0xf
    v_and_b32_dpp v30, v26, v10 row_newbcast:15 row_mask:0xf bank_mask:0xf
    v_and_b32_dpp v31, v26, v11 row_newbcast:15 row_mask:0xf bank_mask:0xf
    v_mfma_f32_16x16x32_bf16 v[12:15], v[244:247], v[32:35], v[12:15]
    v_and_b32_dpp v32, v27, v8 row_newbcast:15 row_mask:0xf bank_mask:0xf
    v_and_b32_dpp v33, v27, v9 row_newbcast:15 row_mask:0xf bank_mask:0xf
    v_and_b32_dpp v34, v27, v10 row_newbcast:15 row_mask:0xf bank_mask:0xf
    v_and_b32_dpp v35, v27, v11 row_newbcast:15 row_mask:0xf bank_mask:0xf
    v_mfma_f32_16x16x32_bf16 v[12:15], v[248:251], v[28:31], v[12:15]
    s_nop 0
    v_mfma_f32_16x16x32_bf16 v[12:15], v[252:255], v[32:35], v[12:15]
    s_nop 7
    s_setpc_b64 s[60:61]
L_codeend:
.section .rodata,"a"
.p2align 6
.amdhsa_kernel recurrent_scan__mha_block_cached__swiglu_ffn__decode_kernel
  .amdhsa_next_free_vgpr 256
  .amdhsa_next_free_sgpr 102
  .amdhsa_accum_offset 256
  .amdhsa_group_segment_fixed_size 0
  .amdhsa_kernarg_size 96
  .amdhsa_user_sgpr_count 2
  .amdhsa_user_sgpr_kernarg_segment_ptr 1
  .amdhsa_system_sgpr_workgroup_id_x 1
  .amdhsa_float_denorm_mode_32 3
.end_amdhsa_kernel
```
